```python
import torch

def _softmax(x, axis=-1):
    return torch.softmax(x, dim=axis)

def _gelu(x):
    return torch.nn.functional.gelu(x, approximate='tanh')

def _silu(x):
    return torch.nn.functional.silu(x)

def _sigmoid(x):
    return torch.sigmoid(x)

def _layernorm(x, axis=-1, eps=1e-05):
    m = x.mean(dim=axis, keepdim=True)
    v = x.var(dim=axis, keepdim=True, unbiased=False)
    return (x - m) / torch.sqrt(v + eps)

def _scatter_add(tgt, idx, src, axis=0):
    return tgt.clone().index_add_(axis, idx, src)

def _segment_sum(src, seg, n):
    out = torch.zeros((n,) + src.shape[1:], dtype=src.dtype)
    return out.index_add_(0, seg, src)

def _pad(x, pw):
    flat = tuple((v for pair in reversed(pw) for v in pair))
    return torch.nn.functional.pad(x, flat)
kernel_name = 'standalone__kv_cache_quant_pre_rope_vs_post_rope__sampling'

def setup_inputs():

    _w = lambda a: (lambda t: t.to(torch.bfloat16) if t.is_floating_point() else t)(torch.as_tensor(a))
    B, Sq, Skv = (16, 8, 4096)
    H, Dh0 = (4, 128)
    G = 128 if 128 > 0 else Dh0
    G = max(2, G // 2 * 2)
    Dh = max(G, Dh0 // G * G)
    Skv = max(Skv, Sq)
    ng = Dh // G
    bits = 2 if 2 > 1 else 4
    bits = max(2, min(8, bits))
    qmax = (1 << bits) - 1
    half = Dh // 2
    inv = 1.0 / 10000.0 ** (torch.arange(half) / max(1, half))
    ang_k = torch.arange(Skv)[:, None] * inv[None, :]
    ang_q = torch.arange(Skv - Sq, Skv)[:, None] * inv[None, :]
    kc = torch.cat([torch.cos(ang_k), torch.cos(ang_k)], dim=-1)
    ks = torch.cat([torch.sin(ang_k), torch.sin(ang_k)], dim=-1)
    qc = torch.cat([torch.cos(ang_q), torch.cos(ang_q)], dim=-1)
    qs = torch.cat([torch.sin(ang_q), torch.sin(ang_q)], dim=-1)
    qk_i = torch.randint(0, qmax + 1, (B, H, Skv, Dh)).to(torch.int32)
    qv_i = torch.randint(0, qmax + 1, (B, H, Skv, Dh)).to(torch.int32)
    ksc = torch.abs((lambda *s: torch.randn(*s, dtype=torch.bfloat16) * 0.4)(B, H, Skv, ng)) * 0.1 + 0.01
    kzp = torch.full((B, H, Skv, ng), qmax / 2.0)
    vsc = torch.abs((lambda *s: torch.randn(*s, dtype=torch.bfloat16) * 0.4)(B, H, Skv, ng)) * 0.1 + 0.01
    vzp = torch.full((B, H, Skv, ng), qmax / 2.0)
    return {'q': _w((lambda *s: torch.randn(*s, dtype=torch.bfloat16) * 6.4)(B, H, Sq, Dh) * 0.5), 'qk': _w(qk_i), 'k_scales': _w(ksc), 'k_zeros': _w(kzp), 'qv': _w(qv_i), 'v_scales': _w(vsc), 'v_zeros': _w(vzp), 'q_cos': _w(qc), 'q_sin': _w(qs), 'k_cos': _w(kc), 'k_sin': _w(ks)}

def reference(q, qk, k_scales, k_zeros, qv, v_scales, v_zeros, q_cos, q_sin, k_cos, k_sin):
    B, H, Sq, Dh = q.shape
    ng = k_scales.shape[-1]
    G = Dh // ng
    half = Dh // 2
    ks = (lambda x, n, axis: torch.repeat_interleave(x, n, dim=axis))(k_scales, G, axis=-1)
    kz = (lambda x, n, axis: torch.repeat_interleave(x, n, dim=axis))(k_zeros, G, axis=-1)
    k = ((lambda x, dt: x.to(dt))(qk, q.dtype) - kz) * ks
    vs = (lambda x, n, axis: torch.repeat_interleave(x, n, dim=axis))(v_scales, G, axis=-1)
    vz = (lambda x, n, axis: torch.repeat_interleave(x, n, dim=axis))(v_zeros, G, axis=-1)
    v = ((lambda x, dt: x.to(dt))(qv, q.dtype) - vz) * vs
    k1 = k[..., :half].clone()
    k2 = k[..., half:].clone()
    krh = torch.concatenate([-k2, k1], axis=-1)
    kr = k * k_cos[None, None, :, :] + krh * k_sin[None, None, :, :]
    q1 = q[..., :half].clone()
    q2 = q[..., half:].clone()
    qrh = torch.concatenate([-q2, q1], axis=-1)
    qr = q * q_cos[None, None, :, :] + qrh * q_sin[None, None, :, :]
    logits = torch.einsum('bhqd,bhkd->bhqk', qr, kr) * float(Dh) ** (-0.5)
    attn = _softmax(logits, axis=-1)
    out = torch.einsum('bhqk,bhkd->bhqd', attn, v)
    return out
```

```asm
; @launch grid=(256,1,1) block=(320,1,1) lds=143872
.amdgcn_target "amdgcn-amd-amdhsa--gfx950"
.text
.globl standalone__kv_cache_quant_pre_rope_vs_post_rope__sampling_kernel
.p2align 8
.type standalone__kv_cache_quant_pre_rope_vs_post_rope__sampling_kernel,@function
standalone__kv_cache_quant_pre_rope_vs_post_rope__sampling_kernel:
    s_cmp_ge_u32 s2, 256
    s_cbranch_scc1 L_end
    s_load_dwordx16 s[16:31], s[0:1], 0
    s_load_dwordx8 s[32:39], s[0:1], 64
    s_load_dwordx2 s[42:43], s[0:1], 104
    v_lshrrev_b32 v2, 6, v0
    v_and_b32 v1, 63, v0
    v_readfirstlane_b32 s3, v2
    s_and_b32 s4, s2, 7
    s_lshr_b32 s5, s2, 3
    s_and_b32 s57, s5, 1
    s_mul_i32 s56, s5, 4352
    s_add_u32 s56, s56, 2162688
    v_lshrrev_b32 v2, 3, v1
    v_and_b32 v3, 7, v1
    v_lshrrev_b32 v4, 5, v1
    v_mov_b32 v23, 143808
    s_mov_b32 s83, 0
    s_cmp_lg_u32 s3, 0
    s_cbranch_scc1 L_consumer
    s_setprio 3
    v_mov_b32 v6, 0
    v_mov_b32 v7, 0
    v_lshlrev_b32 v24, 2, v1
    v_lshl_add_u32 v18, v1, 6, s5
    s_mov_b32 s59, 16
    ds_write_b64 v23, v[6:7] offset:32
    v_xor_b32 v5, v3, v4
    v_lshlrev_b32 v5, 4, v5
    v_lshl_add_u32 v10, v2, 12, v5
    v_lshlrev_b32 v5, 2, v4
    v_xor_b32 v5, v5, v3
    v_lshlrev_b32 v5, 4, v5
    v_lshl_add_u32 v11, v2, 11, v5
    s_lshl_b32 s7, s5, 22
    s_lshl_b32 s6, s4, 15
    s_add_u32 s7, s7, s6
    s_sub_u32 s10, 0x400000, s6
    s_mov_b32 s11, 0x00020000
    s_lshr_b32 s6, s6, 1
    s_sub_u32 s14, 0x100000, s6
    s_mov_b32 s15, 0x00020000
    s_mov_b32 s62, s14
    s_mov_b32 s63, 0x00020000
    s_lshl_b32 s44, s57, 11
    s_lshl_b32 s45, s57, 12
    s_sub_u32 s45, 2048, s45
    s_mov_b32 s46, 0
    s_mov_b32 s47, 0
    s_mov_b32 s48, 0
    v_mov_b32 v12, 0
    v_mov_b32 v13, 0
    v_mov_b32 v14, 0
    v_mov_b32 v15, 0
    s_waitcnt lgkmcnt(0)
    s_add_u32 s8, s18, s7
    s_addc_u32 s9, s19, 0
    s_add_u32 s12, s34, s6
    s_addc_u32 s13, s35, 0
    s_add_u32 s60, s36, s6
    s_addc_u32 s61, s37, 0
    s_mul_i32 s6, s4, 4352
    s_add_u32 s6, s6, 2359296
    s_add_u32 s64, s42, s6
    s_addc_u32 s65, s43, 0
    s_add_u32 s68, s24, s7
    s_addc_u32 s69, s25, 0
    s_mov_b32 s66, 64
    s_mov_b32 s67, 0x00020000
L_k0:
    s_lshr_b32 s49, s44, 1
    s_add_u32 s54, s44, 0x200000
    v_min3_u32 v7, v12, v13, v14
    v_min_u32 v7, v7, v15
    s_sub_u32 s52, s46, 5
    v_readfirstlane_b32 s53, v7
    s_mov_b32 m0, s48
    s_cmp_lt_i32 s53, s52
    s_cbranch_scc1 L_k0_full
    s_add_u32 m0, s48, 0x6000
    s_waitcnt vmcnt(39)
    buffer_load_dwordx4 v11, s[60:63], s49 offen offset:0 lds
    s_addk_i32 m0, 0x380
    s_waitcnt vmcnt(39)
    buffer_load_dwordx4 v11, s[60:63], s49 offen offset:128 lds
    s_addk_i32 m0, 0x380
    s_waitcnt vmcnt(39)
    buffer_load_dwordx4 v11, s[60:63], s49 offen offset:256 lds
    s_addk_i32 m0, 0x380
    s_waitcnt vmcnt(39)
    buffer_load_dwordx4 v11, s[60:63], s49 offen offset:384 lds
    s_addk_i32 m0, 0x380
    s_waitcnt vmcnt(39)
    buffer_load_dwordx4 v11, s[60:63], s49 offen offset:512 lds
    s_addk_i32 m0, 0x380
    s_waitcnt vmcnt(39)
    buffer_load_dwordx4 v11, s[60:63], s49 offen offset:640 lds
    s_addk_i32 m0, 0x380
    s_waitcnt vmcnt(39)
    buffer_load_dwordx4 v11, s[60:63], s49 offen offset:768 lds
    s_addk_i32 m0, 0x380
    s_waitcnt vmcnt(39)
    s_sub_u32 s47, s47, 1
    s_max_i32 s47, s47, 0
    v_mov_b32 v6, s47
    ds_write_b32 v23, v6 offset:32
    buffer_load_dwordx4 v11, s[60:63], s49 offen offset:896 lds
    s_add_u32 m0, s48, 0x0
    s_waitcnt vmcnt(39)
    buffer_load_dwordx4 v10, s[8:11], s44 offen offset:0 nt lds
    s_addk_i32 m0, 0x380
    s_waitcnt vmcnt(39)
    buffer_load_dwordx4 v10, s[8:11], s44 offen offset:128 nt lds
    s_addk_i32 m0, 0x380
    s_waitcnt vmcnt(39)
    buffer_load_dwordx4 v10, s[8:11], s44 offen offset:256 nt lds
    s_addk_i32 m0, 0x380
    s_waitcnt vmcnt(39)
    buffer_load_dwordx4 v10, s[8:11], s44 offen offset:384 nt lds
    s_addk_i32 m0, 0x380
    s_waitcnt vmcnt(39)
    buffer_load_dwordx4 v10, s[8:11], s44 offen offset:512 nt lds
    s_addk_i32 m0, 0x380
    s_waitcnt vmcnt(39)
    ds_read_b128 v[12:15], v23
    buffer_load_dwordx4 v10, s[8:11], s44 offen offset:640 nt lds
    s_addk_i32 m0, 0x380
    s_waitcnt vmcnt(39)
    buffer_load_dwordx4 v10, s[8:11], s44 offen offset:768 nt lds
    s_addk_i32 m0, 0x380
    s_waitcnt vmcnt(39)
    buffer_load_dwordx4 v10, s[8:11], s44 offen offset:896 nt lds
    s_mov_b32 s47, s46
    s_add_u32 s46, s46, 1
    s_add_u32 s48, s48, 0x4000
    s_cmp_lg_u32 s46, 1
    s_cbranch_scc1 L_k1
    s_barrier
    s_load_dwordx2 s[72:73], s[42:43], s56
    v_mov_b32 v19, 0
    buffer_store_byte v19, v18, s[64:67], 0 offen offset:32
L_k1:
    v_min3_u32 v7, v12, v13, v14
    v_min_u32 v7, v7, v15
    s_sub_u32 s52, s46, 5
    v_readfirstlane_b32 s53, v7
    s_mov_b32 m0, s48
    s_cmp_lt_i32 s53, s52
    s_cbranch_scc1 L_k1_full
    s_add_u32 m0, s48, 0xffffdc00
    s_waitcnt vmcnt(39)
    buffer_load_dwordx4 v10, s[8:11], s44 offen offset:1024 nt lds
    s_addk_i32 m0, 0x380
    s_waitcnt vmcnt(39)
    buffer_load_dwordx4 v10, s[8:11], s44 offen offset:1152 nt lds
    s_addk_i32 m0, 0x380
    s_waitcnt vmcnt(39)
    buffer_load_dwordx4 v10, s[8:11], s44 offen offset:1280 nt lds
    s_addk_i32 m0, 0x380
    s_waitcnt vmcnt(39)
    buffer_load_dwordx4 v10, s[8:11], s44 offen offset:1408 nt lds
    s_addk_i32 m0, 0x380
    s_waitcnt vmcnt(39)
    buffer_load_dwordx4 v10, s[8:11], s44 offen offset:1536 nt lds
    s_addk_i32 m0, 0x380
    s_waitcnt vmcnt(39)
    buffer_load_dwordx4 v10, s[8:11], s44 offen offset:1664 nt lds
    s_addk_i32 m0, 0x380
    s_waitcnt vmcnt(39)
    buffer_load_dwordx4 v10, s[8:11], s44 offen offset:1792 nt lds
    s_addk_i32 m0, 0x380
    s_waitcnt vmcnt(39)
    s_sub_u32 s47, s47, 1
    s_max_i32 s47, s47, 0
    v_mov_b32 v6, s47
    ds_write_b32 v23, v6 offset:32
    buffer_load_dwordx4 v10, s[8:11], s44 offen offset:1920 nt lds
    s_add_u32 m0, s48, 0x0
    s_waitcnt vmcnt(39)
    buffer_load_dwordx4 v11, s[12:15], s49 offen offset:0 lds
    s_addk_i32 m0, 0x380
    s_waitcnt vmcnt(39)
    buffer_load_dwordx4 v11, s[12:15], s49 offen offset:128 lds
    s_addk_i32 m0, 0x380
    s_waitcnt vmcnt(39)
    buffer_load_dwordx4 v11, s[12:15], s49 offen offset:256 lds
    s_addk_i32 m0, 0x380
    s_waitcnt vmcnt(39)
    buffer_load_dwordx4 v11, s[12:15], s49 offen offset:384 lds
    s_addk_i32 m0, 0x380
    s_waitcnt vmcnt(39)
    buffer_load_dwordx4 v11, s[12:15], s49 offen offset:512 lds
    s_addk_i32 m0, 0x380
    s_waitcnt vmcnt(39)
    ds_read_b128 v[12:15], v23
    buffer_load_dwordx4 v11, s[12:15], s49 offen offset:640 lds
    s_addk_i32 m0, 0x380
    s_waitcnt vmcnt(39)
    buffer_load_dwordx4 v11, s[12:15], s49 offen offset:768 lds
    s_addk_i32 m0, 0x380
    s_waitcnt vmcnt(39)
    buffer_load_dwordx4 v11, s[12:15], s49 offen offset:896 lds
    s_mov_b32 s47, s46
    s_add_u32 s46, s46, 1
    s_add_u32 s48, s48, 0x4000
L_k2:
    v_min3_u32 v7, v12, v13, v14
    v_min_u32 v7, v7, v15
    s_sub_u32 s52, s46, 5
    v_readfirstlane_b32 s53, v7
    s_mov_b32 m0, s48
    s_cmp_lt_i32 s53, s52
    s_cbranch_scc1 L_k2_full
    s_waitcnt vmcnt(39)
    buffer_load_dwordx4 v10, s[8:11], s54 offen offset:0 nt lds
    s_addk_i32 m0, 0x380
    s_waitcnt vmcnt(39)
    buffer_load_dwordx4 v10, s[8:11], s54 offen offset:128 nt lds
    s_addk_i32 m0, 0x380
    s_waitcnt vmcnt(39)
    buffer_load_dwordx4 v10, s[8:11], s54 offen offset:256 nt lds
    s_addk_i32 m0, 0x380
    s_waitcnt vmcnt(39)
    buffer_load_dwordx4 v10, s[8:11], s54 offen offset:384 nt lds
    s_addk_i32 m0, 0x380
    s_waitcnt vmcnt(39)
    buffer_load_dwordx4 v10, s[8:11], s54 offen offset:512 nt lds
    s_addk_i32 m0, 0x380
    s_waitcnt vmcnt(39)
    buffer_load_dwordx4 v10, s[8:11], s54 offen offset:640 nt lds
    s_addk_i32 m0, 0x380
    s_waitcnt vmcnt(39)
    buffer_load_dwordx4 v10, s[8:11], s54 offen offset:768 nt lds
    s_addk_i32 m0, 0x380
    s_waitcnt vmcnt(39)
    s_sub_u32 s47, s47, 1
    s_max_i32 s47, s47, 0
    v_mov_b32 v6, s47
    ds_write_b32 v23, v6 offset:32
    buffer_load_dwordx4 v10, s[8:11], s54 offen offset:896 nt lds
    s_addk_i32 m0, 0x380
    s_waitcnt vmcnt(39)
    buffer_load_dwordx4 v10, s[8:11], s54 offen offset:1024 nt lds
    s_addk_i32 m0, 0x380
    s_waitcnt vmcnt(39)
    buffer_load_dwordx4 v10, s[8:11], s54 offen offset:1152 nt lds
    s_addk_i32 m0, 0x380
    s_waitcnt vmcnt(39)
    buffer_load_dwordx4 v10, s[8:11], s54 offen offset:1280 nt lds
    s_addk_i32 m0, 0x380
    s_waitcnt vmcnt(39)
    buffer_load_dwordx4 v10, s[8:11], s54 offen offset:1408 nt lds
    s_addk_i32 m0, 0x380
    s_waitcnt vmcnt(39)
    buffer_load_dwordx4 v10, s[8:11], s54 offen offset:1536 nt lds
    s_addk_i32 m0, 0x380
    s_waitcnt vmcnt(39)
    ds_read_b128 v[12:15], v23
    buffer_load_dwordx4 v10, s[8:11], s54 offen offset:1664 nt lds
    s_addk_i32 m0, 0x380
    s_waitcnt vmcnt(39)
    buffer_load_dwordx4 v10, s[8:11], s54 offen offset:1792 nt lds
    s_addk_i32 m0, 0x380
    s_waitcnt vmcnt(39)
    buffer_load_dwordx4 v10, s[8:11], s54 offen offset:1920 nt lds
    s_cmp_ge_u32 s46, 48
    s_cbranch_scc1 L_vnext
    s_mov_b32 s47, s46
    s_add_u32 s46, s46, 1
    s_add_u32 s48, s48, 0x4000
    s_cmp_eq_u32 s48, 98304
    s_cselect_b32 s48, 0, s48
    s_add_u32 s44, s44, s45
    s_sub_u32 s45, 0x40000, s45
    s_add_u32 s59, s59, 2
    s_cmp_eq_u32 s46, 48
    s_cbranch_scc1 L_tov
    v_mov_b32 v19, s59
    buffer_store_byte v19, v18, s[64:67], 0 offen
    s_cmp_lg_u32 s46, 45
    s_cbranch_scc1 L_k0
    buffer_load_dword v22, v24, s[64:67], 0 offen nt
    s_branch L_k0
L_tov:
    s_mov_b32 s8, s68
    s_mov_b32 s9, s69
    s_lshl_b32 s44, s57, 11
    s_mov_b32 s54, s44
    s_add_u32 s55, s5, 46
    s_max_u32 s55, s55, 49
    s_min_u32 s55, s55, 77
    s_mov_b32 s78, s55
    s_lshr_b32 s77, s5, 2
    s_and_b32 s75, s5, 3
    s_lshl_b32 s75, s75, 3
    s_mov_b32 s70, 0
    s_mov_b32 s71, 0
    s_waitcnt lgkmcnt(0)
L_v:
    v_mov_b32 v21, v22
    s_ashr_i32 s53, s70, 2
    v_sad_u8 v20, v21, 0, 0
    v_readlane_b32 s76, v21, s77
    s_sub_u32 s70, s70, s53
    v_add_u32_dpp v20, v20, v20 quad_perm:[1,0,3,2] row_mask:0xf bank_mask:0xf
    s_lshr_b32 s76, s76, s75
    s_and_b32 s76, s76, 0xff
    v_add_u32_dpp v20, v20, v20 quad_perm:[2,3,0,1] row_mask:0xf bank_mask:0xf
    s_lshl_b32 s76, s76, 5
    s_sub_u32 s76, s76, 16
    v_add_u32_dpp v20, v20, v20 row_half_mirror row_mask:0xf bank_mask:0xf
    s_nop 0
    v_readlane_b32 s6, v20, 0
    v_readlane_b32 s52, v20, 8
    s_sub_u32 s6, s6, s76
    s_sub_u32 s53, s52, s71
    s_mov_b32 s71, s52
    s_lshr_b32 s52, s53, 5
    s_mul_i32 s52, s52, 71
    s_lshl_b32 s53, s53, 1
    s_sub_u32 s53, s53, s52
    s_mul_i32 s53, s53, 3
    s_add_u32 s70, s70, s53
    s_ashr_i32 s53, s70, 2
    s_add_u32 s6, s6, s53
    s_mov_b32 s58, 20
    s_cmp_gt_i32 s6, -10
    s_cselect_b32 s58, 22, s58
    s_cmp_gt_i32 s6, 6
    s_cselect_b32 s58, 24, s58
    s_cmp_gt_i32 s6, 13
    s_cselect_b32 s58, 27, s58
    s_cmp_gt_i32 s6, 20
    s_cselect_b32 s58, 40, s58
L_vpost:
    v_mov_b32 v19, s59
    buffer_store_byte v19, v18, s[64:67], 0 offen
    buffer_load_dword v22, v24, s[64:67], 0 offen nt
    s_cmp_lg_u32 s58, 22
    s_cbranch_scc1 L_vsel
L_v22:
    v_min3_u32 v7, v12, v13, v14
    v_min_u32 v7, v7, v15
    s_sub_u32 s52, s46, 5
    v_readfirstlane_b32 s53, v7
    s_mov_b32 m0, s48
    s_cmp_lt_i32 s53, s52
    s_cbranch_scc1 L_v22_full
    s_waitcnt vmcnt(21)
    buffer_load_dwordx4 v10, s[8:11], s54 offen offset:0 nt lds
    s_addk_i32 m0, 0x380
    s_waitcnt vmcnt(21)
    buffer_load_dwordx4 v10, s[8:11], s54 offen offset:128 nt lds
    s_addk_i32 m0, 0x380
    s_waitcnt vmcnt(21)
    buffer_load_dwordx4 v10, s[8:11], s54 offen offset:256 nt lds
    s_addk_i32 m0, 0x380
    s_waitcnt vmcnt(21)
    buffer_load_dwordx4 v10, s[8:11], s54 offen offset:384 nt lds
    s_addk_i32 m0, 0x380
    s_waitcnt vmcnt(21)
    buffer_load_dwordx4 v10, s[8:11], s54 offen offset:512 nt lds
    s_addk_i32 m0, 0x380
    s_waitcnt vmcnt(21)
    v_mov_b32 v6, s47
    ds_write_b32 v23, v6 offset:32
    buffer_load_dwordx4 v10, s[8:11], s54 offen offset:640 nt lds
    s_addk_i32 m0, 0x380
    s_waitcnt vmcnt(21)
    buffer_load_dwordx4 v10, s[8:11], s54 offen offset:768 nt lds
    s_addk_i32 m0, 0x380
    s_waitcnt vmcnt(21)
    buffer_load_dwordx4 v10, s[8:11], s54 offen offset:896 nt lds
    s_addk_i32 m0, 0x380
    s_waitcnt vmcnt(21)
    buffer_load_dwordx4 v10, s[8:11], s54 offen offset:1024 nt lds
    s_addk_i32 m0, 0x380
    s_waitcnt vmcnt(21)
    buffer_load_dwordx4 v10, s[8:11], s54 offen offset:1152 nt lds
    s_addk_i32 m0, 0x380
    s_waitcnt vmcnt(21)
    buffer_load_dwordx4 v10, s[8:11], s54 offen offset:1280 nt lds
    s_addk_i32 m0, 0x380
    s_waitcnt vmcnt(21)
    buffer_load_dwordx4 v10, s[8:11], s54 offen offset:1408 nt lds
    s_addk_i32 m0, 0x380
    s_waitcnt vmcnt(21)
    buffer_load_dwordx4 v10, s[8:11], s54 offen offset:1536 nt lds
    s_addk_i32 m0, 0x380
    s_waitcnt vmcnt(21)
    ds_read_b128 v[12:15], v23
    buffer_load_dwordx4 v10, s[8:11], s54 offen offset:1664 nt lds
    s_addk_i32 m0, 0x380
    s_waitcnt vmcnt(21)
    buffer_load_dwordx4 v10, s[8:11], s54 offen offset:1792 nt lds
    s_addk_i32 m0, 0x380
    s_waitcnt vmcnt(21)
    buffer_load_dwordx4 v10, s[8:11], s54 offen offset:1920 nt lds
L_vnext:
    s_add_u32 s59, s59, 1
    s_mov_b32 s47, s46
    s_add_u32 s46, s46, 1
    s_add_u32 s48, s48, 0x4000
    s_cmp_eq_u32 s48, 98304
    s_cselect_b32 s48, 0, s48
    s_add_u32 s54, s44, 0x200000
    s_bitcmp1_b32 s46, 0
    s_cbranch_scc1 L_vb
    s_add_u32 s44, s44, s45
    s_sub_u32 s45, 0x40000, s45
    s_mov_b32 s54, s44
L_vb:
    s_cmp_lg_u32 s46, s55
    s_cbranch_scc1 L_v
    s_cmp_eq_u32 s46, 80
    s_cbranch_scc1 L_ldone
    s_cmp_lg_u32 s46, s78
    s_cbranch_scc1 L_rank
    s_mov_b32 s74, 1
    s_add_u32 s6, s56, 4
    s_atomic_add s74, s[42:43], s6 glc
    s_add_u32 s55, s55, 2
    s_branch L_v
L_rank:
    s_waitcnt lgkmcnt(0)
    s_sub_u32 s6, s74, s73
    s_and_b32 s6, s6, 7
    s_or_b32 s6, s6, 32
    v_mov_b32 v19, s6
    buffer_store_byte v19, v18, s[64:67], 0 offen offset:32
    s_mov_b32 s55, 80
    s_branch L_v
L_ldone:
    s_cmp_lg_u32 s4, 0
    s_cbranch_scc1 L_noep
    s_mov_b32 s74, 1
    s_atomic_add s74, s[42:43], s56
L_noep:
    v_mov_b32 v6, 78
    s_waitcnt vmcnt(32)
    ds_write_b32 v23, v6 offset:32
    s_waitcnt vmcnt(16)
    v_mov_b32 v6, s47
    ds_write_b32 v23, v6 offset:32
    s_mov_b32 s47, 80
    s_waitcnt vmcnt(8)
    s_barrier
    s_waitcnt vmcnt(0)
    s_barrier
    s_endpgm
L_vsel:
    s_cmp_eq_u32 s58, 20
    s_cbranch_scc1 L_v20
    s_cmp_eq_u32 s58, 24
    s_cbranch_scc1 L_v24
    s_cmp_eq_u32 s58, 27
    s_cbranch_scc1 L_v27
    s_branch L_k2
L_v20:
    v_min3_u32 v7, v12, v13, v14
    v_min_u32 v7, v7, v15
    s_sub_u32 s52, s46, 5
    v_readfirstlane_b32 s53, v7
    s_mov_b32 m0, s48
    s_cmp_lt_i32 s53, s52
    s_cbranch_scc1 L_v20_full
    s_waitcnt vmcnt(19)
    buffer_load_dwordx4 v10, s[8:11], s54 offen offset:0 nt lds
    s_addk_i32 m0, 0x380
    s_waitcnt vmcnt(19)
    buffer_load_dwordx4 v10, s[8:11], s54 offen offset:128 nt lds
    s_addk_i32 m0, 0x380
    s_waitcnt vmcnt(19)
    buffer_load_dwordx4 v10, s[8:11], s54 offen offset:256 nt lds
    s_addk_i32 m0, 0x380
    s_waitcnt vmcnt(19)
    v_mov_b32 v6, s47
    ds_write_b32 v23, v6 offset:32
    buffer_load_dwordx4 v10, s[8:11], s54 offen offset:384 nt lds
    s_addk_i32 m0, 0x380
    s_waitcnt vmcnt(19)
    buffer_load_dwordx4 v10, s[8:11], s54 offen offset:512 nt lds
    s_addk_i32 m0, 0x380
    s_waitcnt vmcnt(19)
    buffer_load_dwordx4 v10, s[8:11], s54 offen offset:640 nt lds
    s_addk_i32 m0, 0x380
    s_waitcnt vmcnt(19)
    buffer_load_dwordx4 v10, s[8:11], s54 offen offset:768 nt lds
    s_addk_i32 m0, 0x380
    s_waitcnt vmcnt(19)
    buffer_load_dwordx4 v10, s[8:11], s54 offen offset:896 nt lds
    s_addk_i32 m0, 0x380
    s_waitcnt vmcnt(19)
    buffer_load_dwordx4 v10, s[8:11], s54 offen offset:1024 nt lds
    s_addk_i32 m0, 0x380
    s_waitcnt vmcnt(19)
    buffer_load_dwordx4 v10, s[8:11], s54 offen offset:1152 nt lds
    s_addk_i32 m0, 0x380
    s_waitcnt vmcnt(19)
    buffer_load_dwordx4 v10, s[8:11], s54 offen offset:1280 nt lds
    s_addk_i32 m0, 0x380
    s_waitcnt vmcnt(19)
    buffer_load_dwordx4 v10, s[8:11], s54 offen offset:1408 nt lds
    s_addk_i32 m0, 0x380
    s_waitcnt vmcnt(19)
    buffer_load_dwordx4 v10, s[8:11], s54 offen offset:1536 nt lds
    s_addk_i32 m0, 0x380
    s_waitcnt vmcnt(19)
    ds_read_b128 v[12:15], v23
    buffer_load_dwordx4 v10, s[8:11], s54 offen offset:1664 nt lds
    s_addk_i32 m0, 0x380
    s_waitcnt vmcnt(19)
    buffer_load_dwordx4 v10, s[8:11], s54 offen offset:1792 nt lds
    s_addk_i32 m0, 0x380
    s_waitcnt vmcnt(19)
    buffer_load_dwordx4 v10, s[8:11], s54 offen offset:1920 nt lds
    s_branch L_vnext
L_v24:
    v_min3_u32 v7, v12, v13, v14
    v_min_u32 v7, v7, v15
    s_sub_u32 s52, s46, 5
    v_readfirstlane_b32 s53, v7
    s_mov_b32 m0, s48
    s_cmp_lt_i32 s53, s52
    s_cbranch_scc1 L_v24_full
    s_waitcnt vmcnt(23)
    buffer_load_dwordx4 v10, s[8:11], s54 offen offset:0 nt lds
    s_addk_i32 m0, 0x380
    s_waitcnt vmcnt(23)
    buffer_load_dwordx4 v10, s[8:11], s54 offen offset:128 nt lds
    s_addk_i32 m0, 0x380
    s_waitcnt vmcnt(23)
    buffer_load_dwordx4 v10, s[8:11], s54 offen offset:256 nt lds
    s_addk_i32 m0, 0x380
    s_waitcnt vmcnt(23)
    buffer_load_dwordx4 v10, s[8:11], s54 offen offset:384 nt lds
    s_addk_i32 m0, 0x380
    s_waitcnt vmcnt(23)
    buffer_load_dwordx4 v10, s[8:11], s54 offen offset:512 nt lds
    s_addk_i32 m0, 0x380
    s_waitcnt vmcnt(23)
    buffer_load_dwordx4 v10, s[8:11], s54 offen offset:640 nt lds
    s_addk_i32 m0, 0x380
    s_waitcnt vmcnt(23)
    buffer_load_dwordx4 v10, s[8:11], s54 offen offset:768 nt lds
    s_addk_i32 m0, 0x380
    s_waitcnt vmcnt(23)
    v_mov_b32 v6, s47
    ds_write_b32 v23, v6 offset:32
    buffer_load_dwordx4 v10, s[8:11], s54 offen offset:896 nt lds
    s_addk_i32 m0, 0x380
    s_waitcnt vmcnt(23)
    buffer_load_dwordx4 v10, s[8:11], s54 offen offset:1024 nt lds
    s_addk_i32 m0, 0x380
    s_waitcnt vmcnt(23)
    buffer_load_dwordx4 v10, s[8:11], s54 offen offset:1152 nt lds
    s_addk_i32 m0, 0x380
    s_waitcnt vmcnt(23)
    buffer_load_dwordx4 v10, s[8:11], s54 offen offset:1280 nt lds
    s_addk_i32 m0, 0x380
    s_waitcnt vmcnt(23)
    buffer_load_dwordx4 v10, s[8:11], s54 offen offset:1408 nt lds
    s_addk_i32 m0, 0x380
    s_waitcnt vmcnt(23)
    buffer_load_dwordx4 v10, s[8:11], s54 offen offset:1536 nt lds
    s_addk_i32 m0, 0x380
    s_waitcnt vmcnt(23)
    ds_read_b128 v[12:15], v23
    buffer_load_dwordx4 v10, s[8:11], s54 offen offset:1664 nt lds
    s_addk_i32 m0, 0x380
    s_waitcnt vmcnt(23)
    buffer_load_dwordx4 v10, s[8:11], s54 offen offset:1792 nt lds
    s_addk_i32 m0, 0x380
    s_waitcnt vmcnt(23)
    buffer_load_dwordx4 v10, s[8:11], s54 offen offset:1920 nt lds
    s_branch L_vnext
L_v27:
    v_min3_u32 v7, v12, v13, v14
    v_min_u32 v7, v7, v15
    s_sub_u32 s52, s46, 5
    v_readfirstlane_b32 s53, v7
    s_mov_b32 m0, s48
    s_cmp_lt_i32 s53, s52
    s_cbranch_scc1 L_v27_full
    s_waitcnt vmcnt(26)
    buffer_load_dwordx4 v10, s[8:11], s54 offen offset:0 nt lds
    s_addk_i32 m0, 0x380
    s_waitcnt vmcnt(26)
    buffer_load_dwordx4 v10, s[8:11], s54 offen offset:128 nt lds
    s_addk_i32 m0, 0x380
    s_waitcnt vmcnt(26)
    buffer_load_dwordx4 v10, s[8:11], s54 offen offset:256 nt lds
    s_addk_i32 m0, 0x380
    s_waitcnt vmcnt(26)
    buffer_load_dwordx4 v10, s[8:11], s54 offen offset:384 nt lds
    s_addk_i32 m0, 0x380
    s_waitcnt vmcnt(26)
    buffer_load_dwordx4 v10, s[8:11], s54 offen offset:512 nt lds
    s_addk_i32 m0, 0x380
    s_waitcnt vmcnt(26)
    buffer_load_dwordx4 v10, s[8:11], s54 offen offset:640 nt lds
    s_addk_i32 m0, 0x380
    s_waitcnt vmcnt(26)
    buffer_load_dwordx4 v10, s[8:11], s54 offen offset:768 nt lds
    s_addk_i32 m0, 0x380
    s_waitcnt vmcnt(26)
    buffer_load_dwordx4 v10, s[8:11], s54 offen offset:896 nt lds
    s_addk_i32 m0, 0x380
    s_waitcnt vmcnt(26)
    buffer_load_dwordx4 v10, s[8:11], s54 offen offset:1024 nt lds
    s_addk_i32 m0, 0x380
    s_waitcnt vmcnt(26)
    buffer_load_dwordx4 v10, s[8:11], s54 offen offset:1152 nt lds
    s_addk_i32 m0, 0x380
    s_waitcnt vmcnt(26)
    v_mov_b32 v6, s47
    ds_write_b32 v23, v6 offset:32
    buffer_load_dwordx4 v10, s[8:11], s54 offen offset:1280 nt lds
    s_addk_i32 m0, 0x380
    s_waitcnt vmcnt(26)
    buffer_load_dwordx4 v10, s[8:11], s54 offen offset:1408 nt lds
    s_addk_i32 m0, 0x380
    s_waitcnt vmcnt(26)
    buffer_load_dwordx4 v10, s[8:11], s54 offen offset:1536 nt lds
    s_addk_i32 m0, 0x380
    s_waitcnt vmcnt(26)
    ds_read_b128 v[12:15], v23
    buffer_load_dwordx4 v10, s[8:11], s54 offen offset:1664 nt lds
    s_addk_i32 m0, 0x380
    s_waitcnt vmcnt(26)
    buffer_load_dwordx4 v10, s[8:11], s54 offen offset:1792 nt lds
    s_addk_i32 m0, 0x380
    s_waitcnt vmcnt(26)
    buffer_load_dwordx4 v10, s[8:11], s54 offen offset:1920 nt lds
    s_branch L_vnext
L_k0_full:
    ds_read_b128 v[12:15], v23
    s_add_u32 s83, s83, 1
    s_cmp_gt_u32 s83, 4194304
    s_cbranch_scc1 L_end
    s_waitcnt lgkmcnt(0)
    s_branch L_k0
L_k1_full:
    ds_read_b128 v[12:15], v23
    s_add_u32 s83, s83, 1
    s_cmp_gt_u32 s83, 4194304
    s_cbranch_scc1 L_end
    s_waitcnt lgkmcnt(0)
    s_branch L_k1
L_k2_full:
    ds_read_b128 v[12:15], v23
    s_add_u32 s83, s83, 1
    s_cmp_gt_u32 s83, 4194304
    s_cbranch_scc1 L_end
    s_waitcnt lgkmcnt(0)
    s_branch L_k2
L_v22_full:
    ds_read_b128 v[12:15], v23
    s_add_u32 s83, s83, 1
    s_cmp_gt_u32 s83, 4194304
    s_cbranch_scc1 L_end
    s_waitcnt lgkmcnt(0)
    s_branch L_v22
L_v20_full:
    ds_read_b128 v[12:15], v23
    s_add_u32 s83, s83, 1
    s_cmp_gt_u32 s83, 4194304
    s_cbranch_scc1 L_end
    s_waitcnt lgkmcnt(0)
    s_branch L_v20
L_v24_full:
    ds_read_b128 v[12:15], v23
    s_add_u32 s83, s83, 1
    s_cmp_gt_u32 s83, 4194304
    s_cbranch_scc1 L_end
    s_waitcnt lgkmcnt(0)
    s_branch L_v24
L_v27_full:
    ds_read_b128 v[12:15], v23
    s_add_u32 s83, s83, 1
    s_cmp_gt_u32 s83, 4194304
    s_cbranch_scc1 L_end
    s_waitcnt lgkmcnt(0)
    s_branch L_v27
L_consumer:
    s_sub_u32 s3, s3, 1
    s_mov_b32 s80, 0xffff0000
    s_mov_b32 s81, 0x3e0293ee
    s_lshl_b32 s14, s5, 12
    v_lshlrev_b32 v14, 4, v1
    s_mov_b32 s79, 0x00020000
    s_lshl_b32 s7, s3, 2
    v_add_u32 v17, s7, v23
    v_mov_b32 v24, 0
    ds_write_b32 v17, v24
    ds_write_b32 v17, v24 offset:16
    s_waitcnt lgkmcnt(0)
    s_barrier
    s_load_dword s82, s[42:43], s56
    s_cmp_lg_u32 s3, 0
    s_cbranch_scc1 L_notq
    v_lshlrev_b32 v22, 4, v3
    v_lshl_add_u32 v22, v2, 8, v22
    s_mov_b32 s76, s30
    s_mov_b32 s77, s31
    s_mov_b32 s78, 2048
    buffer_load_dwordx4 v[72:75], v22, s[76:79], 0 offen
    buffer_load_dwordx4 v[76:79], v22, s[76:79], 0 offen offset:128
    s_mov_b32 s76, s32
    s_mov_b32 s77, s33
    buffer_load_dwordx4 v[80:83], v22, s[76:79], 0 offen
    buffer_load_dwordx4 v[84:87], v22, s[76:79], 0 offen offset:128
    s_mov_b32 s76, s16
    s_mov_b32 s77, s17
    s_mov_b32 s78, 131072
    buffer_load_dwordx4 v[136:139], v22, s[76:79], s14 offen offset:0
    buffer_load_dwordx4 v[140:143], v22, s[76:79], s14 offen offset:128
    buffer_load_dwordx4 v[144:147], v22, s[76:79], s14 offen offset:2048
    buffer_load_dwordx4 v[148:151], v22, s[76:79], s14 offen offset:2176
    s_branch L_roles
L_notq:
    s_cmp_lg_u32 s3, 1
    s_cbranch_scc1 L_notsc
    v_lshlrev_b32 v22, 4, v3
    v_lshl_add_u32 v22, v2, 10, v22
    s_lshl_b32 s6, s5, 14
    s_lshl_b32 s7, s4, 7
    s_add_u32 s6, s6, s7
    s_add_u32 s7, s6, 8192
    s_mov_b32 s78, 0x80000
    s_mov_b32 m0, 131072
    s_mov_b32 s76, s22
    s_mov_b32 s77, s23
    buffer_load_dwordx4 v22, s[76:79], s6 offen lds
    s_addk_i32 m0, 0x400
    s_nop 0
    buffer_load_dwordx4 v22, s[76:79], s7 offen lds
    s_mov_b32 m0, 133120
    s_mov_b32 s76, s20
    s_mov_b32 s77, s21
    buffer_load_dwordx4 v22, s[76:79], s6 offen lds
    s_addk_i32 m0, 0x400
    s_nop 0
    buffer_load_dwordx4 v22, s[76:79], s7 offen lds
    s_branch L_roles
L_notsc:
    s_cmp_lg_u32 s3, 2
    s_cbranch_scc1 L_roles
    s_lshr_b32 s6, s5, 2
    s_lshl_b32 s6, s6, 3
    s_add_u32 s6, s6, s4
    s_lshl_b32 s6, s6, 14
    s_and_b32 s7, s5, 3
    s_lshl_b32 s7, s7, 12
    s_add_u32 s6, s6, s7
    v_lshlrev_b32 v22, 7, v1
    s_mov_b32 s76, s34
    s_mov_b32 s77, s35
    s_mov_b32 s78, 0x100000
    s_mov_b32 exec_hi, 0
    buffer_load_dword v136, v22, s[76:79], s6 offen
    s_mov_b32 s76, s36
    s_mov_b32 s77, s37
    buffer_load_dword v137, v22, s[76:79], s6 offen
    s_mov_b64 exec, -1
L_roles:
    v_bfe_u32 v5, v1, 1, 3
    s_lshl_b32 s6, s57, 2
    s_add_u32 s6, s6, s3
    v_lshl_add_u32 v12, v5, 3, s6
    v_lshlrev_b32 v12, 1, v12
    v_add_u32 v12, 131072, v12
    v_lshl_add_u32 v13, v2, 3, s6
    v_lshlrev_b32 v13, 1, v13
    v_add_u32 v13, 133120, v13
    v_lshrrev_b32 v22, 4, v1
    v_and_b32 v26, 1, v1
    v_lshl_add_u32 v22, v22, 1, v26
    v_and_b32 v26, 4, v5
    v_xor_b32 v26, v26, v22
    v_lshlrev_b32 v26, 4, v26
    v_lshl_add_u32 v9, v5, 7, v26
    s_lshl_b32 s7, s3, 11
    s_add_u32 s7, s7, 0x4000
    v_add_u32 v9, s7, v9
    s_lshl_b32 s7, s3, 12
    v_lshlrev_b32 v6, 10, v4
    v_lshl_add_u32 v6, v5, 7, v6
    v_and_b32 v22, 3, v22
    v_lshl_add_u32 v6, v22, 5, v6
    v_lshrrev_b32 v22, 2, v5
    v_lshl_add_u32 v6, v22, 4, v6
    v_add_u32 v6, s7, v6
    s_lshl_b32 s7, s3, 2
    s_lshl_b32 s6, s57, 10
    s_add_u32 s7, s7, s6
    s_add_u32 s7, s7, 98304
    v_add_u32 v11, s7, v14
    v_mov_b32 v25, 0
    v_mov_b32 v18, 0xff7fffff
    v_mov_b32 v21, 0xff7fffff
    s_mov_b32 s12, 1
    s_mov_b32 s13, 0
    s_mov_b32 s8, 0
    s_lshl_b32 s9, s57, 4
    s_sub_u32 s9, 8, s9
    s_lshl_b32 s11, s57, 11
    s_add_u32 s11, s11, 1024
    s_cmp_eq_u32 s3, 2
    s_cselect_b32 s10, 46, 0
    s_cmp_lg_u32 s3, 0
    s_cbranch_scc1 L_qdone
    s_waitcnt vmcnt(4)
    v_lshlrev_b32 v88, 16, v72
    v_and_b32 v89, s80, v72
    v_lshlrev_b32 v90, 16, v73
    v_and_b32 v91, s80, v73
    v_lshlrev_b32 v92, 16, v74
    v_and_b32 v93, s80, v74
    v_lshlrev_b32 v94, 16, v75
    v_and_b32 v95, s80, v75
    v_lshlrev_b32 v96, 16, v76
    v_and_b32 v97, s80, v76
    v_lshlrev_b32 v98, 16, v77
    v_and_b32 v99, s80, v77
    v_lshlrev_b32 v100, 16, v78
    v_and_b32 v101, s80, v78
    v_lshlrev_b32 v102, 16, v79
    v_and_b32 v103, s80, v79
    v_lshlrev_b32 v104, 16, v80
    v_and_b32 v105, s80, v80
    v_lshlrev_b32 v106, 16, v81
    v_and_b32 v107, s80, v81
    v_lshlrev_b32 v108, 16, v82
    v_and_b32 v109, s80, v82
    v_lshlrev_b32 v110, 16, v83
    v_and_b32 v111, s80, v83
    v_lshlrev_b32 v112, 16, v84
    v_and_b32 v113, s80, v84
    v_lshlrev_b32 v114, 16, v85
    v_and_b32 v115, s80, v85
    v_lshlrev_b32 v116, 16, v86
    v_and_b32 v117, s80, v86
    v_lshlrev_b32 v118, 16, v87
    v_and_b32 v119, s80, v87
    v_lshl_add_u32 v22, v3, 3, v2
    v_lshlrev_b32 v22, 4, v22
    v_add_u32 v22, 139264, v22
    s_waitcnt vmcnt(2)
    v_lshlrev_b32 v56, 16, v136
    v_and_b32 v57, s80, v136
    v_lshlrev_b32 v58, 16, v137
    v_and_b32 v59, s80, v137
    v_lshlrev_b32 v60, 16, v138
    v_and_b32 v61, s80, v138
    v_lshlrev_b32 v62, 16, v139
    v_and_b32 v63, s80, v139
    v_lshlrev_b32 v64, 16, v140
    v_and_b32 v65, s80, v140
    v_lshlrev_b32 v66, 16, v141
    v_and_b32 v67, s80, v141
    v_lshlrev_b32 v68, 16, v142
    v_and_b32 v69, s80, v142
    v_lshlrev_b32 v70, 16, v143
    v_and_b32 v71, s80, v143
    v_pk_mul_f32 v[120:121], v[56:57], v[88:89]
    v_pk_mul_f32 v[128:129], v[64:65], v[96:97]
    v_pk_mul_f32 v[122:123], v[58:59], v[90:91]
    v_pk_mul_f32 v[130:131], v[66:67], v[98:99]
    v_pk_mul_f32 v[124:125], v[60:61], v[92:93]
    v_pk_mul_f32 v[132:133], v[68:69], v[100:101]
    v_pk_mul_f32 v[126:127], v[62:63], v[94:95]
    v_pk_mul_f32 v[134:135], v[70:71], v[102:103]
    v_pk_fma_f32 v[120:121], v[64:65], v[104:105], v[120:121] neg_lo:[1,0,0] neg_hi:[1,0,0]
    v_pk_fma_f32 v[128:129], v[56:57], v[112:113], v[128:129]
    v_pk_fma_f32 v[122:123], v[66:67], v[106:107], v[122:123] neg_lo:[1,0,0] neg_hi:[1,0,0]
    v_pk_fma_f32 v[130:131], v[58:59], v[114:115], v[130:131]
    v_pk_fma_f32 v[124:125], v[68:69], v[108:109], v[124:125] neg_lo:[1,0,0] neg_hi:[1,0,0]
    v_pk_fma_f32 v[132:133], v[60:61], v[116:117], v[132:133]
    v_pk_fma_f32 v[126:127], v[70:71], v[110:111], v[126:127] neg_lo:[1,0,0] neg_hi:[1,0,0]
    v_pk_fma_f32 v[134:135], v[62:63], v[118:119], v[134:135]
    v_cvt_pk_bf16_f32 v32, v120, v121
    v_cvt_pk_bf16_f32 v36, v128, v129
    v_cvt_pk_bf16_f32 v33, v122, v123
    v_cvt_pk_bf16_f32 v37, v130, v131
    v_cvt_pk_bf16_f32 v34, v124, v125
    v_cvt_pk_bf16_f32 v38, v132, v133
    v_cvt_pk_bf16_f32 v35, v126, v127
    v_cvt_pk_bf16_f32 v39, v134, v135
    ds_write_b128 v22, v[32:35] offset:0
    ds_write_b128 v22, v[36:39] offset:1024
    s_waitcnt vmcnt(0)
    v_lshlrev_b32 v56, 16, v144
    v_and_b32 v57, s80, v144
    v_lshlrev_b32 v58, 16, v145
    v_and_b32 v59, s80, v145
    v_lshlrev_b32 v60, 16, v146
    v_and_b32 v61, s80, v146
    v_lshlrev_b32 v62, 16, v147
    v_and_b32 v63, s80, v147
    v_lshlrev_b32 v64, 16, v148
    v_and_b32 v65, s80, v148
    v_lshlrev_b32 v66, 16, v149
    v_and_b32 v67, s80, v149
    v_lshlrev_b32 v68, 16, v150
    v_and_b32 v69, s80, v150
    v_lshlrev_b32 v70, 16, v151
    v_and_b32 v71, s80, v151
    v_pk_mul_f32 v[120:121], v[56:57], v[88:89]
    v_pk_mul_f32 v[128:129], v[64:65], v[96:97]
    v_pk_mul_f32 v[122:123], v[58:59], v[90:91]
    v_pk_mul_f32 v[130:131], v[66:67], v[98:99]
    v_pk_mul_f32 v[124:125], v[60:61], v[92:93]
    v_pk_mul_f32 v[132:133], v[68:69], v[100:101]
    v_pk_mul_f32 v[126:127], v[62:63], v[94:95]
    v_pk_mul_f32 v[134:135], v[70:71], v[102:103]
    v_pk_fma_f32 v[120:121], v[64:65], v[104:105], v[120:121] neg_lo:[1,0,0] neg_hi:[1,0,0]
    v_pk_fma_f32 v[128:129], v[56:57], v[112:113], v[128:129]
    v_pk_fma_f32 v[122:123], v[66:67], v[106:107], v[122:123] neg_lo:[1,0,0] neg_hi:[1,0,0]
    v_pk_fma_f32 v[130:131], v[58:59], v[114:115], v[130:131]
    v_pk_fma_f32 v[124:125], v[68:69], v[108:109], v[124:125] neg_lo:[1,0,0] neg_hi:[1,0,0]
    v_pk_fma_f32 v[132:133], v[60:61], v[116:117], v[132:133]
    v_pk_fma_f32 v[126:127], v[70:71], v[110:111], v[126:127] neg_lo:[1,0,0] neg_hi:[1,0,0]
    v_pk_fma_f32 v[134:135], v[62:63], v[118:119], v[134:135]
    v_cvt_pk_bf16_f32 v40, v120, v121
    v_cvt_pk_bf16_f32 v44, v128, v129
    v_cvt_pk_bf16_f32 v41, v122, v123
    v_cvt_pk_bf16_f32 v45, v130, v131
    v_cvt_pk_bf16_f32 v42, v124, v125
    v_cvt_pk_bf16_f32 v46, v132, v133
    v_cvt_pk_bf16_f32 v43, v126, v127
    v_cvt_pk_bf16_f32 v47, v134, v135
    ds_write_b128 v22, v[40:43] offset:2048
    ds_write_b128 v22, v[44:47] offset:3072
L_qdone:
    v_mov_b32 v22, 1
    s_waitcnt vmcnt(0) lgkmcnt(0)
    ds_write_b32 v17, v22 offset:16
L_ws0:
    ds_read_b128 v[28:31], v23 offset:16
    s_add_u32 s83, s83, 1
    s_cmp_gt_u32 s83, 4194304
    s_cbranch_scc1 L_end
    s_waitcnt lgkmcnt(0)
    v_min3_u32 v22, v28, v29, v30
    v_min_u32 v22, v22, v31
    s_nop 0
    v_readfirstlane_b32 s6, v22
    s_cmp_ge_u32 s6, 1
    s_cbranch_scc0 L_ws0
    v_add_u32 v26, 139264, v14
    ds_read_b128 v[32:35], v26 offset:0
    ds_read_b128 v[36:39], v26 offset:1024
    ds_read_b128 v[40:43], v26 offset:2048
    ds_read_b128 v[44:47], v26 offset:3072
L_kunit:
    s_sub_u32 s11, 2048, s11
    v_add_u32 v7, s8, v6
    v_add_u32 v10, s8, v9
    v_xor_b32 v8, 16, v7
    s_cmp_eq_u32 s12, s10
    s_cbranch_scc1 L_vscales
L_kgo:
    s_cmp_gt_u32 s13, s12
    s_cbranch_scc1 L_wl1_ok
L_wl1:
    ds_read_b32 v22, v23 offset:32
    s_add_u32 s83, s83, 1
    s_cmp_gt_u32 s83, 4194304
    s_cbranch_scc1 L_end
    s_waitcnt lgkmcnt(0)
    v_readfirstlane_b32 s13, v22
    s_cmp_gt_u32 s13, s12
    s_cbranch_scc0 L_wl1
L_wl1_ok:
    ds_read_b128 v[72:75], v10 offset:0
    ds_read_b128 v[76:79], v10 offset:1024
    ds_read_b128 v[80:83], v10 offset:8192
    ds_read_b128 v[84:87], v10 offset:9216
    ds_read_b128 v[56:59], v7 offset:0
    ds_read_b128 v[64:67], v7 offset:2048
    ds_read_u16_d16_hi v24, v12 offset:0
    ds_read_b128 v[60:63], v8 offset:0
    ds_read_b128 v[68:71], v8 offset:2048
    ds_read_u16_d16_hi v25, v13 offset:0
    s_waitcnt lgkmcnt(8)
    v_lshlrev_b32 v88, 16, v72
    v_and_b32 v89, s80, v72
    v_lshlrev_b32 v90, 16, v73
    v_and_b32 v91, s80, v73
    v_lshlrev_b32 v92, 16, v74
    v_and_b32 v93, s80, v74
    v_lshlrev_b32 v94, 16, v75
    v_and_b32 v95, s80, v75
    v_lshlrev_b32 v96, 16, v76
    v_and_b32 v97, s80, v76
    v_lshlrev_b32 v98, 16, v77
    v_and_b32 v99, s80, v77
    v_lshlrev_b32 v100, 16, v78
    v_and_b32 v101, s80, v78
    v_lshlrev_b32 v102, 16, v79
    v_and_b32 v103, s80, v79
    s_waitcnt lgkmcnt(0)
    s_add_u32 s6, s12, 1
    v_mov_b32 v22, s6
    ds_write_b32 v17, v22
    s_add_u32 s12, s12, 1
    v_lshlrev_b32 v104, 16, v80
    v_and_b32 v105, s80, v80
    v_lshlrev_b32 v106, 16, v81
    v_and_b32 v107, s80, v81
    v_lshlrev_b32 v108, 16, v82
    v_and_b32 v109, s80, v82
    v_lshlrev_b32 v110, 16, v83
    v_and_b32 v111, s80, v83
    v_lshlrev_b32 v112, 16, v84
    v_and_b32 v113, s80, v84
    v_lshlrev_b32 v114, 16, v85
    v_and_b32 v115, s80, v85
    v_lshlrev_b32 v116, 16, v86
    v_and_b32 v117, s80, v86
    v_lshlrev_b32 v118, 16, v87
    v_and_b32 v119, s80, v87
    v_cvt_f32_i32 v56, v56
    v_cvt_f32_i32 v57, v57
    v_cvt_f32_i32 v58, v58
    v_cvt_f32_i32 v59, v59
    v_cvt_f32_i32 v64, v64
    v_cvt_f32_i32 v65, v65
    v_cvt_f32_i32 v66, v66
    v_cvt_f32_i32 v67, v67
    v_pk_add_f32 v[56:57], v[56:57], v[24:25] op_sel_hi:[1,0] neg_lo:[0,1] neg_hi:[0,1]
    v_pk_add_f32 v[58:59], v[58:59], v[24:25] op_sel_hi:[1,0] neg_lo:[0,1] neg_hi:[0,1]
    v_pk_add_f32 v[64:65], v[64:65], v[24:25] op_sel_hi:[1,0] neg_lo:[0,1] neg_hi:[0,1]
    v_pk_add_f32 v[66:67], v[66:67], v[24:25] op_sel_hi:[1,0] neg_lo:[0,1] neg_hi:[0,1]
    v_pk_mul_f32 v[120:121], v[56:57], v[88:89]
    v_pk_mul_f32 v[128:129], v[64:65], v[96:97]
    v_pk_mul_f32 v[122:123], v[58:59], v[90:91]
    v_pk_mul_f32 v[130:131], v[66:67], v[98:99]
    v_pk_fma_f32 v[120:121], v[64:65], v[104:105], v[120:121] neg_lo:[1,0,0] neg_hi:[1,0,0]
    v_pk_fma_f32 v[128:129], v[56:57], v[112:113], v[128:129]
    v_pk_fma_f32 v[122:123], v[66:67], v[106:107], v[122:123] neg_lo:[1,0,0] neg_hi:[1,0,0]
    v_pk_fma_f32 v[130:131], v[58:59], v[114:115], v[130:131]
    v_cvt_pk_bf16_f32 v48, v120, v121
    v_cvt_pk_bf16_f32 v52, v128, v129
    v_cvt_pk_bf16_f32 v49, v122, v123
    v_cvt_pk_bf16_f32 v53, v130, v131
    v_cvt_f32_i32 v60, v60
    v_cvt_f32_i32 v61, v61
    v_cvt_f32_i32 v62, v62
    v_cvt_f32_i32 v63, v63
    v_cvt_f32_i32 v68, v68
    v_cvt_f32_i32 v69, v69
    v_cvt_f32_i32 v70, v70
    v_cvt_f32_i32 v71, v71
    v_pk_add_f32 v[60:61], v[60:61], v[24:25] op_sel_hi:[1,0] neg_lo:[0,1] neg_hi:[0,1]
    v_pk_add_f32 v[62:63], v[62:63], v[24:25] op_sel_hi:[1,0] neg_lo:[0,1] neg_hi:[0,1]
    v_pk_add_f32 v[68:69], v[68:69], v[24:25] op_sel_hi:[1,0] neg_lo:[0,1] neg_hi:[0,1]
    v_pk_add_f32 v[70:71], v[70:71], v[24:25] op_sel_hi:[1,0] neg_lo:[0,1] neg_hi:[0,1]
    v_pk_mul_f32 v[124:125], v[60:61], v[92:93]
    v_pk_mul_f32 v[132:133], v[68:69], v[100:101]
    v_pk_mul_f32 v[126:127], v[62:63], v[94:95]
    v_pk_mul_f32 v[134:135], v[70:71], v[102:103]
    v_pk_fma_f32 v[124:125], v[68:69], v[108:109], v[124:125] neg_lo:[1,0,0] neg_hi:[1,0,0]
    v_pk_fma_f32 v[132:133], v[60:61], v[116:117], v[132:133]
    v_pk_fma_f32 v[126:127], v[70:71], v[110:111], v[126:127] neg_lo:[1,0,0] neg_hi:[1,0,0]
    v_pk_fma_f32 v[134:135], v[62:63], v[118:119], v[134:135]
    v_cvt_pk_bf16_f32 v50, v124, v125
    v_cvt_pk_bf16_f32 v54, v132, v133
    v_cvt_pk_bf16_f32 v51, v126, v127
    v_cvt_pk_bf16_f32 v55, v134, v135
    v_mul_f32 v26, s81, v25
    s_nop 0
    v_mfma_f32_16x16x32_bf16 v[28:31], v[48:51], v[32:35], 0
    v_mfma_f32_16x16x32_bf16 v[28:31], v[52:55], v[36:39], v[28:31]
    s_nop 7
    v_add_f32_dpp v27, v29, v28 row_ror:8 row_mask:0xf bank_mask:0x3
    v_add_f32_dpp v27, v30, v31 row_ror:8 row_mask:0xf bank_mask:0xc
    v_mul_f32 v27, v27, v26
    ds_write_b32 v11, v27 offset:0
    v_max_f32 v18, v18, v27
    s_cmp_gt_u32 s13, s12
    s_cbranch_scc1 L_wl2_ok
L_wl2:
    ds_read_b32 v22, v23 offset:32
    s_add_u32 s83, s83, 1
    s_cmp_gt_u32 s83, 4194304
    s_cbranch_scc1 L_end
    s_waitcnt lgkmcnt(0)
    v_readfirstlane_b32 s13, v22
    s_cmp_gt_u32 s13, s12
    s_cbranch_scc0 L_wl2
L_wl2_ok:
    ds_read_b128 v[56:59], v7 offset:32768
    ds_read_b128 v[64:67], v7 offset:34816
    ds_read_u16_d16_hi v24, v12 offset:1024
    ds_read_b128 v[60:63], v8 offset:32768
    ds_read_b128 v[68:71], v8 offset:34816
    ds_read_u16_d16_hi v25, v13 offset:1024
    s_waitcnt lgkmcnt(3)
    v_cvt_f32_i32 v56, v56
    v_cvt_f32_i32 v57, v57
    v_cvt_f32_i32 v58, v58
    v_cvt_f32_i32 v59, v59
    v_cvt_f32_i32 v64, v64
    v_cvt_f32_i32 v65, v65
    v_cvt_f32_i32 v66, v66
    v_cvt_f32_i32 v67, v67
    v_pk_add_f32 v[56:57], v[56:57], v[24:25] op_sel_hi:[1,0] neg_lo:[0,1] neg_hi:[0,1]
    v_pk_add_f32 v[58:59], v[58:59], v[24:25] op_sel_hi:[1,0] neg_lo:[0,1] neg_hi:[0,1]
    v_pk_add_f32 v[64:65], v[64:65], v[24:25] op_sel_hi:[1,0] neg_lo:[0,1] neg_hi:[0,1]
    v_pk_add_f32 v[66:67], v[66:67], v[24:25] op_sel_hi:[1,0] neg_lo:[0,1] neg_hi:[0,1]
    v_pk_mul_f32 v[120:121], v[56:57], v[88:89]
    v_pk_mul_f32 v[128:129], v[64:65], v[96:97]
    v_pk_mul_f32 v[122:123], v[58:59], v[90:91]
    v_pk_mul_f32 v[130:131], v[66:67], v[98:99]
    v_pk_fma_f32 v[120:121], v[64:65], v[104:105], v[120:121] neg_lo:[1,0,0] neg_hi:[1,0,0]
    v_pk_fma_f32 v[128:129], v[56:57], v[112:113], v[128:129]
    v_pk_fma_f32 v[122:123], v[66:67], v[106:107], v[122:123] neg_lo:[1,0,0] neg_hi:[1,0,0]
    v_pk_fma_f32 v[130:131], v[58:59], v[114:115], v[130:131]
    v_cvt_pk_bf16_f32 v48, v120, v121
    v_cvt_pk_bf16_f32 v52, v128, v129
    v_cvt_pk_bf16_f32 v49, v122, v123
    v_cvt_pk_bf16_f32 v53, v130, v131
    s_waitcnt lgkmcnt(0)
    s_add_u32 s6, s12, 1
    v_mov_b32 v22, s6
    ds_write_b32 v17, v22
    s_add_u32 s12, s12, 2
    v_cvt_f32_i32 v60, v60
    v_cvt_f32_i32 v61, v61
    v_cvt_f32_i32 v62, v62
    v_cvt_f32_i32 v63, v63
    v_cvt_f32_i32 v68, v68
    v_cvt_f32_i32 v69, v69
    v_cvt_f32_i32 v70, v70
    v_cvt_f32_i32 v71, v71
    v_pk_add_f32 v[60:61], v[60:61], v[24:25] op_sel_hi:[1,0] neg_lo:[0,1] neg_hi:[0,1]
    v_pk_add_f32 v[62:63], v[62:63], v[24:25] op_sel_hi:[1,0] neg_lo:[0,1] neg_hi:[0,1]
    v_pk_add_f32 v[68:69], v[68:69], v[24:25] op_sel_hi:[1,0] neg_lo:[0,1] neg_hi:[0,1]
    v_pk_add_f32 v[70:71], v[70:71], v[24:25] op_sel_hi:[1,0] neg_lo:[0,1] neg_hi:[0,1]
    v_pk_mul_f32 v[124:125], v[60:61], v[92:93]
    v_pk_mul_f32 v[132:133], v[68:69], v[100:101]
    v_pk_mul_f32 v[126:127], v[62:63], v[94:95]
    v_pk_mul_f32 v[134:135], v[70:71], v[102:103]
    v_pk_fma_f32 v[124:125], v[68:69], v[108:109], v[124:125] neg_lo:[1,0,0] neg_hi:[1,0,0]
    v_pk_fma_f32 v[132:133], v[60:61], v[116:117], v[132:133]
    v_pk_fma_f32 v[126:127], v[70:71], v[110:111], v[126:127] neg_lo:[1,0,0] neg_hi:[1,0,0]
    v_pk_fma_f32 v[134:135], v[62:63], v[118:119], v[134:135]
    v_cvt_pk_bf16_f32 v50, v124, v125
    v_cvt_pk_bf16_f32 v54, v132, v133
    v_cvt_pk_bf16_f32 v51, v126, v127
    v_cvt_pk_bf16_f32 v55, v134, v135
    v_mul_f32 v26, s81, v25
    s_nop 0
    v_mfma_f32_16x16x32_bf16 v[28:31], v[48:51], v[40:43], 0
    v_mfma_f32_16x16x32_bf16 v[28:31], v[52:55], v[44:47], v[28:31]
    v_add_u32 v12, s9, v12
    v_add_u32 v13, s9, v13
    s_sub_u32 s9, 128, s9
    s_sub_u32 s8, 0xc000, s8
    s_cmp_lt_u32 s12, 48
    s_nop 2
    v_add_f32_dpp v27, v29, v28 row_ror:8 row_mask:0xf bank_mask:0x3
    v_add_f32_dpp v27, v30, v31 row_ror:8 row_mask:0xf bank_mask:0xc
    v_mul_f32 v27, v27, v26
    ds_write_b32 v11, v27 offset:16384
    v_max_f32 v21, v21, v27
    v_add_u32 v11, s11, v11
    s_cbranch_scc1 L_kunit
    s_mov_b32 s12, 48
    v_max_f32_dpp v18, v18, v18 row_ror:8 row_mask:0xf bank_mask:0xf
    v_max_f32_dpp v21, v21, v21 row_ror:8 row_mask:0xf bank_mask:0xf
    v_mov_b32 v26, v18
    v_mov_b32 v27, v21
    v_lshlrev_b32 v5, 4, v3
    v_add_u32 v5, 143360, v5
    v_permlane16_swap_b32 v18, v26
    v_permlane16_swap_b32 v21, v27
    v_max_f32 v18, v18, v26
    v_max_f32 v21, v21, v27
    v_mov_b32 v26, v18
    v_mov_b32 v27, v21
    s_lshl_b32 s7, s3, 2
    v_add_u32 v24, s7, v5
    v_permlane32_swap_b32 v18, v26
    v_permlane32_swap_b32 v21, v27
    v_max_f32 v18, v18, v26
    v_max_f32 v21, v21, v27
    ds_write_b32 v24, v18
    ds_write_b32 v24, v21 offset:128
    v_lshlrev_b32 v6, 4, v4
    v_xor_b32 v6, v6, v14
    s_lshl_b32 s7, s3, 10
    v_add_u32 v6, s7, v6
    v_add_u32 v8, 98304, v14
    v_lshlrev_b32 v13, 4, v2
    v_add_u32 v13, 135168, v13
    v_add_u32 v15, 2097152, v14
    s_lshl_b32 s7, s3, 13
    v_add_u32 v11, s7, v8
    s_lshl_b32 s7, s3, 9
    v_add_u32 v10, s7, v13
    s_lshl_b32 s7, s57, 3
    v_add_u32 v8, s7, v8
    v_add_u32 v13, s7, v13
    v_bfe_u32 v44, v1, 3, 2
    v_lshl_add_u32 v44, v44, 1, v4
    s_lshl_b32 s7, s3, 7
    v_lshl_add_u32 v26, v3, 4, s7
    v_lshl_add_u32 v14, v44, 9, v26
    v_lshl_add_u32 v46, v44, 12, v26
    v_cmp_ne_u32 s[62:63], s4, v44
    v_bfe_u32 v16, v1, 4, 1
    v_lshl_add_u32 v16, v16, 1, v4
    v_lshrrev_b32 v26, 1, v26
    v_lshl_add_u32 v16, v16, 1, v26
    s_lshl_b32 s7, s4, 8
    s_add_u32 s14, s14, s7
    s_lshl_b32 s66, s5, 16
    s_lshl_b32 s7, s4, 12
    s_add_u32 s10, s66, s7
    s_add_u32 s15, s10, 0x8000
    s_lshl_b32 s7, s4, 9
    s_add_u32 s66, s66, s7
    s_add_u32 s67, s66, 0x8000
    s_mov_b32 s68, s42
    s_mov_b32 s69, s43
    s_mov_b32 s70, 2162688
    s_mov_b32 s71, 0x00020000
    s_mov_b32 s72, s38
    s_mov_b32 s73, s39
    s_mov_b32 s74, 131072
    s_mov_b32 s75, 0x00020000
    s_mul_i32 s82, s82, 0x9e3779b1
    s_add_u32 s82, s82, 0x7f4a7c15
    s_bfe_u32 s90, s82, 0x80000
    s_bfe_u32 s91, s82, 0x80008
    s_bfe_u32 s92, s82, 0x80010
    s_bfe_u32 s93, s82, 0x80018
    v_mov_b32 v45, 0xffffff00
    s_mov_b32 s8, 0
    v_mov_b32 v20, 0
    v_mov_b32 v21, 0
    s_lshr_b32 s7, s3, 1
    s_lshl_b32 s6, s7, 7
    v_add_u32 v25, s6, v5
    v_mov_b32 v22, 2
    s_waitcnt vmcnt(0) lgkmcnt(0)
    ds_write_b32 v17, v22 offset:16
L_ws3:
    ds_read_b128 v[28:31], v23 offset:16
    s_add_u32 s83, s83, 1
    s_cmp_gt_u32 s83, 4194304
    s_cbranch_scc1 L_end
    s_waitcnt lgkmcnt(0)
    v_min3_u32 v22, v28, v29, v30
    v_min_u32 v22, v22, v31
    s_nop 0
    v_readfirstlane_b32 s6, v22
    s_cmp_ge_u32 s6, 2
    s_cbranch_scc0 L_ws3
    ds_read_b128 v[28:31], v25
    s_mov_b32 s11, 4
    s_waitcnt lgkmcnt(0)
    v_max3_f32 v18, v28, v29, v30
    v_max_f32 v18, v18, v31
L_pblk:
    ds_read_b128 v[72:75], v11
    ds_read_b128 v[76:79], v11 offset:1024
    ds_read_b128 v[84:87], v10
    v_add_u32 v10, 128, v10
    s_sub_u32 s11, s11, 1
    s_cmp_lg_u32 s11, 0
    s_waitcnt lgkmcnt(1)
    v_pk_add_f32 v[72:73], v[72:73], v[18:19] op_sel_hi:[1,0] neg_lo:[0,1] neg_hi:[0,1]
    v_pk_add_f32 v[74:75], v[74:75], v[18:19] op_sel_hi:[1,0] neg_lo:[0,1] neg_hi:[0,1]
    v_pk_add_f32 v[76:77], v[76:77], v[18:19] op_sel_hi:[1,0] neg_lo:[0,1] neg_hi:[0,1]
    v_pk_add_f32 v[78:79], v[78:79], v[18:19] op_sel_hi:[1,0] neg_lo:[0,1] neg_hi:[0,1]
    v_exp_f32 v72, v72
    v_exp_f32 v73, v73
    v_exp_f32 v74, v74
    v_exp_f32 v75, v75
    v_exp_f32 v76, v76
    v_exp_f32 v77, v77
    v_exp_f32 v78, v78
    v_exp_f32 v79, v79
    s_waitcnt lgkmcnt(0)
    v_lshlrev_b32 v36, 16, v84
    v_and_b32 v37, s80, v84
    v_lshlrev_b32 v38, 16, v85
    v_and_b32 v39, s80, v85
    v_lshlrev_b32 v40, 16, v86
    v_and_b32 v41, s80, v86
    v_lshlrev_b32 v42, 16, v87
    v_and_b32 v43, s80, v87
    v_pk_mul_f32 v[36:37], v[36:37], v[72:73]
    v_pk_mul_f32 v[38:39], v[38:39], v[74:75]
    v_pk_mul_f32 v[40:41], v[40:41], v[76:77]
    v_pk_mul_f32 v[42:43], v[42:43], v[78:79]
    v_cvt_pk_bf16_f32 v80, v36, v37
    v_cvt_pk_bf16_f32 v81, v38, v39
    v_cvt_pk_bf16_f32 v82, v40, v41
    v_cvt_pk_bf16_f32 v83, v42, v43
    ds_write_b128 v11, v[80:83]
    v_pk_add_f32 v[20:21], v[20:21], v[72:73]
    v_pk_add_f32 v[20:21], v[20:21], v[74:75]
    v_pk_add_f32 v[20:21], v[20:21], v[76:77]
    v_pk_add_f32 v[20:21], v[20:21], v[78:79]
    v_add_u32 v11, 2048, v11
    s_cbranch_scc1 L_pblk
    v_add_f32 v19, v20, v21
    s_lshl_b32 s6, s7, 3
    v_add_u32 v5, s6, v5
    v_add_f32_dpp v19, v19, v19 row_ror:8 row_mask:0xf bank_mask:0xf
    v_mov_b32 v26, v19
    s_nop 1
    v_permlane16_swap_b32 v19, v26
    v_add_f32 v19, v19, v26
    v_mov_b32 v26, v19
    s_nop 1
    v_permlane32_swap_b32 v19, v26
    v_add_f32 v19, v19, v26
    ds_write_b32 v24, v19 offset:256
    v_mov_b32 v88, 0
    v_mov_b32 v89, 0
    v_mov_b32 v90, 0
    v_mov_b32 v91, 0
    v_mov_b32 v92, 0
    v_mov_b32 v93, 0
    v_mov_b32 v94, 0
    v_mov_b32 v95, 0
    v_mov_b32 v96, 0
    v_mov_b32 v97, 0
    v_mov_b32 v98, 0
    v_mov_b32 v99, 0
    v_mov_b32 v100, 0
    v_mov_b32 v101, 0
    v_mov_b32 v102, 0
    v_mov_b32 v103, 0
    v_mov_b32 v104, 0
    v_mov_b32 v105, 0
    v_mov_b32 v106, 0
    v_mov_b32 v107, 0
    v_mov_b32 v108, 0
    v_mov_b32 v109, 0
    v_mov_b32 v110, 0
    v_mov_b32 v111, 0
    v_mov_b32 v112, 0
    v_mov_b32 v113, 0
    v_mov_b32 v114, 0
    v_mov_b32 v115, 0
    v_mov_b32 v116, 0
    v_mov_b32 v117, 0
    v_mov_b32 v118, 0
    v_mov_b32 v119, 0
    v_mov_b32 v120, 0
    v_mov_b32 v121, 0
    v_mov_b32 v122, 0
    v_mov_b32 v123, 0
    v_mov_b32 v124, 0
    v_mov_b32 v125, 0
    v_mov_b32 v126, 0
    v_mov_b32 v127, 0
    v_mov_b32 v22, 3
    s_waitcnt vmcnt(0) lgkmcnt(0)
    ds_write_b32 v17, v22 offset:16
L_ws4:
    ds_read_b128 v[28:31], v23 offset:16
    s_add_u32 s83, s83, 1
    s_cmp_gt_u32 s83, 4194304
    s_cbranch_scc1 L_end
    s_waitcnt lgkmcnt(0)
    v_min3_u32 v22, v28, v29, v30
    v_min_u32 v22, v22, v31
    s_nop 0
    v_readfirstlane_b32 s6, v22
    s_cmp_ge_u32 s6, 3
    s_cbranch_scc0 L_ws4
    s_mov_b32 s11, 79
    s_bitcmp0_b32 s3, 0
    s_cbranch_scc1 L_vunit
    s_mov_b32 s11, 55
    ds_read_b64 v[20:21], v5 offset:256
    s_lshl_b32 s65, s7, 10
    s_lshl_b32 s6, s5, 11
    s_add_u32 s65, s65, s6
    s_lshl_b32 s6, s4, 7
    s_add_u32 s6, s6, s65
    s_waitcnt lgkmcnt(0)
    v_add_f32 v19, v20, v21
    v_mov_b32 v20, s82
    v_mov_b32 v21, s83
    s_mov_b64 exec, 0xff
    buffer_store_dwordx4 v[18:21], v15, s[68:71], s6 offen sc1
    s_mov_b64 exec, -1
L_vunit:
    ds_read_b64 v[80:81], v8
    ds_read_b64 v[82:83], v8 offset:16384
    ds_read_b64 v[32:33], v13 offset:2048
    ds_read_b64 v[34:35], v13 offset:3072
    s_cmp_gt_i32 s9, 64
    s_cselect_b32 s6, 1920, 0
    s_add_u32 s6, s6, s9
    v_add_u32 v8, s6, v8
    v_add_u32 v13, s9, v13
    s_sub_u32 s9, 128, s9
    v_add_u32 v7, s8, v6
    s_cmp_eq_u32 s12, 78
    s_waitcnt lgkmcnt(0)
    v_mfma_f32_16x16x16_bf16 v[104:107], v[80:81], v[32:33], v[104:107]
    v_mfma_f32_16x16x16_bf16 v[124:127], v[82:83], v[34:35], v[124:127]
    s_cbranch_scc1 L_pre
L_vgo:
    s_cmp_gt_u32 s13, s12
    s_cbranch_scc1 L_wl5_ok
L_wl5:
    ds_read_b32 v22, v23 offset:32
    s_add_u32 s83, s83, 1
    s_cmp_gt_u32 s83, 4194304
    s_cbranch_scc1 L_end
    s_waitcnt lgkmcnt(0)
    v_readfirstlane_b32 s13, v22
    s_cmp_gt_u32 s13, s12
    s_cbranch_scc0 L_wl5
L_wl5_ok:
    ds_read_b128 v[56:59], v7 offset:0
    ds_read_b128 v[60:63], v7 offset:4096
    ds_read_b128 v[64:67], v7 offset:8192
    ds_read_b128 v[68:71], v7 offset:12288
    s_waitcnt lgkmcnt(2)
    v_cvt_f32_i32 v56, v56
    v_cvt_f32_i32 v57, v57
    v_cvt_f32_i32 v58, v58
    v_cvt_f32_i32 v59, v59
    v_cvt_f32_i32 v60, v60
    v_cvt_f32_i32 v61, v61
    v_cvt_f32_i32 v62, v62
    v_cvt_f32_i32 v63, v63
    v_cvt_pk_bf16_f32 v48, v56, v60
    v_cvt_pk_bf16_f32 v50, v57, v61
    v_cvt_pk_bf16_f32 v52, v58, v62
    v_cvt_pk_bf16_f32 v54, v59, v63
    s_waitcnt lgkmcnt(0)
    v_cvt_f32_i32 v64, v64
    v_cvt_f32_i32 v65, v65
    v_cvt_f32_i32 v66, v66
    v_cvt_f32_i32 v67, v67
    v_cvt_f32_i32 v68, v68
    v_cvt_f32_i32 v69, v69
    v_cvt_f32_i32 v70, v70
    v_cvt_f32_i32 v71, v71
    v_cvt_pk_bf16_f32 v49, v64, v68
    v_cvt_pk_bf16_f32 v51, v65, v69
    v_cvt_pk_bf16_f32 v53, v66, v70
    v_cvt_pk_bf16_f32 v55, v67, v71
    v_mfma_f32_16x16x16_bf16 v[88:91], v[80:81], v[48:49], v[88:91]
    v_mfma_f32_16x16x16_bf16 v[92:95], v[80:81], v[50:51], v[92:95]
    v_mfma_f32_16x16x16_bf16 v[96:99], v[80:81], v[52:53], v[96:99]
    v_mfma_f32_16x16x16_bf16 v[100:103], v[80:81], v[54:55], v[100:103]
    s_add_u32 s6, s12, 1
    v_mov_b32 v22, s6
    ds_write_b32 v17, v22
    s_add_u32 s12, s12, 1
    s_cmp_eq_u32 s12, s11
    s_cbranch_scc1 L_hook
L_vmid:
    s_cmp_gt_u32 s13, s12
    s_cbranch_scc1 L_wl6_ok
L_wl6:
    ds_read_b32 v22, v23 offset:32
    s_add_u32 s83, s83, 1
    s_cmp_gt_u32 s83, 4194304
    s_cbranch_scc1 L_end
    s_waitcnt lgkmcnt(0)
    v_readfirstlane_b32 s13, v22
    s_cmp_gt_u32 s13, s12
    s_cbranch_scc0 L_wl6
L_wl6_ok:
    ds_read_b128 v[56:59], v7 offset:16384
    ds_read_b128 v[60:63], v7 offset:20480
    ds_read_b128 v[64:67], v7 offset:24576
    ds_read_b128 v[68:71], v7 offset:28672
    s_waitcnt lgkmcnt(2)
    v_cvt_f32_i32 v56, v56
    v_cvt_f32_i32 v57, v57
    v_cvt_f32_i32 v58, v58
    v_cvt_f32_i32 v59, v59
    v_cvt_f32_i32 v60, v60
    v_cvt_f32_i32 v61, v61
    v_cvt_f32_i32 v62, v62
    v_cvt_f32_i32 v63, v63
    v_cvt_pk_bf16_f32 v48, v56, v60
    v_cvt_pk_bf16_f32 v50, v57, v61
    v_cvt_pk_bf16_f32 v52, v58, v62
    v_cvt_pk_bf16_f32 v54, v59, v63
    s_waitcnt lgkmcnt(0)
    v_cvt_f32_i32 v64, v64
    v_cvt_f32_i32 v65, v65
    v_cvt_f32_i32 v66, v66
    v_cvt_f32_i32 v67, v67
    v_cvt_f32_i32 v68, v68
    v_cvt_f32_i32 v69, v69
    v_cvt_f32_i32 v70, v70
    v_cvt_f32_i32 v71, v71
    v_cvt_pk_bf16_f32 v49, v64, v68
    v_cvt_pk_bf16_f32 v51, v65, v69
    v_cvt_pk_bf16_f32 v53, v66, v70
    v_cvt_pk_bf16_f32 v55, v67, v71
    v_mfma_f32_16x16x16_bf16 v[108:111], v[82:83], v[48:49], v[108:111]
    v_mfma_f32_16x16x16_bf16 v[112:115], v[82:83], v[50:51], v[112:115]
    v_mfma_f32_16x16x16_bf16 v[116:119], v[82:83], v[52:53], v[116:119]
    v_mfma_f32_16x16x16_bf16 v[120:123], v[82:83], v[54:55], v[120:123]
    s_add_u32 s6, s12, 1
    v_mov_b32 v22, s6
    ds_write_b32 v17, v22
    s_add_u32 s12, s12, 1
    s_add_u32 s8, s8, 0x8000
    s_cmp_eq_u32 s8, 98304
    s_cselect_b32 s8, 0, s8
    s_branch L_vunit
L_vscales:
    v_lshlrev_b32 v22, 4, v3
    v_lshl_add_u32 v22, v2, 10, v22
    s_lshl_b32 s6, s5, 14
    s_lshl_b32 s7, s4, 7
    s_add_u32 s6, s6, s7
    s_add_u32 s7, s6, 8192
    s_mov_b32 s78, 0x80000
    s_mov_b32 m0, 135168
    s_mov_b32 s76, s26
    s_mov_b32 s77, s27
    buffer_load_dwordx4 v22, s[76:79], s6 offen lds
    s_addk_i32 m0, 0x400
    s_nop 0
    buffer_load_dwordx4 v22, s[76:79], s7 offen lds
    s_mov_b32 m0, 137216
    s_mov_b32 s76, s28
    s_mov_b32 s77, s29
    buffer_load_dwordx4 v22, s[76:79], s6 offen lds
    s_addk_i32 m0, 0x400
    s_nop 0
    buffer_load_dwordx4 v22, s[76:79], s7 offen lds
    s_branch L_kgo
L_hook:
    s_cmp_eq_u32 s12, 79
    s_cbranch_scc1 L_last
    s_cmp_lg_u32 s12, 55
    s_cbranch_scc1 L_fac
L_mlre:
    buffer_load_dwordx4 v[72:75], v15, s[68:71], s65 offen sc1
    s_add_u32 s11, s12, 2
    s_cmp_lt_u32 s12, 59
    s_cbranch_scc1 L_vmid
    s_add_u32 s83, s83, 1
    s_cmp_gt_u32 s83, 4194304
    s_cbranch_scc1 L_end
L_fac:
    s_waitcnt vmcnt(0)
    v_cmp_ne_u32 vcc, s82, v74
    v_mov_b32 v27, v72
    s_cbranch_vccnz L_mlre
    s_mov_b32 s11, 79
    s_nop 0
    v_max_f32_dpp v27, v27, v27 row_ror:8 row_mask:0xf bank_mask:0xf
    v_mov_b32 v26, v27
    s_nop 1
    v_permlane16_swap_b32 v27, v26
    v_max_f32 v27, v27, v26
    v_mov_b32 v26, v27
    s_nop 1
    v_permlane32_swap_b32 v27, v26
    v_max_f32 v27, v27, v26
    v_sub_f32 v72, v72, v27
    v_sub_f32 v18, v18, v27
    v_exp_f32 v72, v72
    v_exp_f32 v18, v18
    v_mul_f32 v72, v72, v73
    s_lshl_b32 s6, s3, 1
    s_add_u32 s6, s6, 143742
    v_add_f32_dpp v72, v72, v72 row_ror:8 row_mask:0xf bank_mask:0xf
    v_mov_b32 v26, v72
    s_nop 1
    v_permlane16_swap_b32 v72, v26
    v_add_f32 v72, v72, v26
    v_mov_b32 v26, v72
    s_nop 1
    v_permlane32_swap_b32 v72, v26
    v_add_f32 v72, v72, v26
    v_rcp_f32 v72, v72
    v_lshl_add_u32 v26, v3, 3, s6
    v_mul_f32 v18, v18, v72
    v_mov_b32 v22, 4
    ds_write_b32 v26, v18
    ds_write_b32 v17, v22 offset:16
    s_branch L_vmid
L_pre:
    v_lshlrev_b32 v26, 3, v44
    v_add_u32 v26, 143744, v26
L_fw:
    ds_read_b128 v[28:31], v23 offset:16
    ds_read_b64 v[40:41], v26
    s_add_u32 s83, s83, 1
    s_cmp_gt_u32 s83, 4194304
    s_cbranch_scc1 L_end
    s_waitcnt lgkmcnt(0)
    v_min_u32 v22, v29, v31
    s_mov_b32 s64, 0x00ff00ff
    v_readfirstlane_b32 s6, v22
    s_mov_b32 s65, 0x00ff00ff
    s_cmp_ge_u32 s6, 4
    s_cbranch_scc0 L_fw
    v_pk_add_f32 v[88:89], v[88:89], v[104:105] neg_lo:[0,1] neg_hi:[0,1]
    v_pk_add_f32 v[90:91], v[90:91], v[106:107] neg_lo:[0,1] neg_hi:[0,1]
    v_pk_add_f32 v[92:93], v[92:93], v[104:105] neg_lo:[0,1] neg_hi:[0,1]
    v_pk_add_f32 v[94:95], v[94:95], v[106:107] neg_lo:[0,1] neg_hi:[0,1]
    v_pk_add_f32 v[96:97], v[96:97], v[104:105] neg_lo:[0,1] neg_hi:[0,1]
    v_pk_add_f32 v[98:99], v[98:99], v[106:107] neg_lo:[0,1] neg_hi:[0,1]
    v_pk_add_f32 v[100:101], v[100:101], v[104:105] neg_lo:[0,1] neg_hi:[0,1]
    v_pk_add_f32 v[102:103], v[102:103], v[106:107] neg_lo:[0,1] neg_hi:[0,1]
    v_pk_add_f32 v[108:109], v[108:109], v[124:125] neg_lo:[0,1] neg_hi:[0,1]
    v_pk_add_f32 v[110:111], v[110:111], v[126:127] neg_lo:[0,1] neg_hi:[0,1]
    v_pk_add_f32 v[112:113], v[112:113], v[124:125] neg_lo:[0,1] neg_hi:[0,1]
    v_pk_add_f32 v[114:115], v[114:115], v[126:127] neg_lo:[0,1] neg_hi:[0,1]
    v_pk_add_f32 v[116:117], v[116:117], v[124:125] neg_lo:[0,1] neg_hi:[0,1]
    v_pk_add_f32 v[118:119], v[118:119], v[126:127] neg_lo:[0,1] neg_hi:[0,1]
    v_pk_add_f32 v[120:121], v[120:121], v[124:125] neg_lo:[0,1] neg_hi:[0,1]
    v_pk_add_f32 v[122:123], v[122:123], v[126:127] neg_lo:[0,1] neg_hi:[0,1]
    s_branch L_vgo
L_last:
    v_permlane32_swap_b32 v88, v89
    v_permlane32_swap_b32 v90, v91
    v_permlane32_swap_b32 v92, v93
    v_permlane32_swap_b32 v94, v95
    v_permlane32_swap_b32 v96, v97
    v_permlane32_swap_b32 v98, v99
    v_permlane32_swap_b32 v100, v101
    v_permlane32_swap_b32 v102, v103
    v_add_f32_dpp v72, v89, v88 row_ror:8 row_mask:0xf bank_mask:0x3
    v_add_f32_dpp v72, v90, v91 row_ror:8 row_mask:0xf bank_mask:0xc
    v_add_f32_dpp v73, v93, v92 row_ror:8 row_mask:0xf bank_mask:0x3
    v_add_f32_dpp v73, v94, v95 row_ror:8 row_mask:0xf bank_mask:0xc
    v_add_f32_dpp v74, v97, v96 row_ror:8 row_mask:0xf bank_mask:0x3
    v_add_f32_dpp v74, v98, v99 row_ror:8 row_mask:0xf bank_mask:0xc
    v_add_f32_dpp v75, v101, v100 row_ror:8 row_mask:0xf bank_mask:0x3
    v_add_f32_dpp v75, v102, v103 row_ror:8 row_mask:0xf bank_mask:0xc
    v_pk_mul_f32 v[72:73], v[72:73], v[40:41] op_sel_hi:[1,0]
    v_pk_mul_f32 v[74:75], v[74:75], v[40:41] op_sel_hi:[1,0]
    v_and_or_b32 v72, v72, v45, s90
    v_and_or_b32 v73, v73, v45, s91
    v_and_or_b32 v74, v74, v45, s92
    v_and_or_b32 v75, v75, v45, s93
    s_mov_b64 exec, s[62:63]
    buffer_store_dwordx4 v[72:75], v14, s[68:71], s10 offen sc1
    s_mov_b64 exec, -1
    v_mov_b32 v27, 0
    s_barrier
    ds_read_b128 v[56:59], v7 offset:16384
    ds_read_b128 v[60:63], v7 offset:20480
    s_waitcnt lgkmcnt(0)
    v_cvt_f32_i32 v56, v56
    v_cvt_f32_i32 v57, v57
    v_cvt_f32_i32 v58, v58
    v_cvt_f32_i32 v59, v59
    v_cvt_f32_i32 v60, v60
    v_cvt_f32_i32 v61, v61
    v_cvt_f32_i32 v62, v62
    v_cvt_f32_i32 v63, v63
    v_cvt_pk_bf16_f32 v48, v56, v60
    v_cvt_pk_bf16_f32 v50, v57, v61
    v_cvt_pk_bf16_f32 v52, v58, v62
    v_cvt_pk_bf16_f32 v54, v59, v63
    s_barrier
    ds_read_b128 v[64:67], v7 offset:24576
    ds_read_b128 v[68:71], v7 offset:28672
    s_mov_b64 exec, s[62:63]
    buffer_load_dwordx4 v[76:79], v46, s[68:71], s66 offen sc1
    buffer_load_dwordx4 v[84:87], v46, s[68:71], s67 offen sc1
    s_mov_b64 exec, -1
    s_waitcnt lgkmcnt(1)
    v_cvt_f32_i32 v64, v64
    v_cvt_f32_i32 v65, v65
    v_cvt_f32_i32 v66, v66
    v_cvt_f32_i32 v67, v67
    s_waitcnt lgkmcnt(0)
    v_cvt_f32_i32 v68, v68
    v_cvt_f32_i32 v69, v69
    v_cvt_f32_i32 v70, v70
    v_cvt_f32_i32 v71, v71
    v_cvt_pk_bf16_f32 v49, v64, v68
    v_cvt_pk_bf16_f32 v51, v65, v69
    v_cvt_pk_bf16_f32 v53, v66, v70
    v_cvt_pk_bf16_f32 v55, v67, v71
    v_mfma_f32_16x16x16_bf16 v[108:111], v[82:83], v[48:49], v[108:111]
    v_mfma_f32_16x16x16_bf16 v[112:115], v[82:83], v[50:51], v[112:115]
    v_mfma_f32_16x16x16_bf16 v[116:119], v[82:83], v[52:53], v[116:119]
    v_mfma_f32_16x16x16_bf16 v[120:123], v[82:83], v[54:55], v[120:123]
    s_nop 4
    v_permlane32_swap_b32 v108, v109
    v_permlane32_swap_b32 v110, v111
    v_permlane32_swap_b32 v112, v113
    v_permlane32_swap_b32 v114, v115
    v_permlane32_swap_b32 v116, v117
    v_permlane32_swap_b32 v118, v119
    v_permlane32_swap_b32 v120, v121
    v_permlane32_swap_b32 v122, v123
    v_add_f32_dpp v28, v109, v108 row_ror:8 row_mask:0xf bank_mask:0x3
    v_add_f32_dpp v28, v110, v111 row_ror:8 row_mask:0xf bank_mask:0xc
    v_add_f32_dpp v29, v113, v112 row_ror:8 row_mask:0xf bank_mask:0x3
    v_add_f32_dpp v29, v114, v115 row_ror:8 row_mask:0xf bank_mask:0xc
    v_add_f32_dpp v30, v117, v116 row_ror:8 row_mask:0xf bank_mask:0x3
    v_add_f32_dpp v30, v118, v119 row_ror:8 row_mask:0xf bank_mask:0xc
    v_add_f32_dpp v31, v121, v120 row_ror:8 row_mask:0xf bank_mask:0x3
    v_add_f32_dpp v31, v122, v123 row_ror:8 row_mask:0xf bank_mask:0xc
    v_pk_mul_f32 v[28:29], v[28:29], v[40:41] op_sel:[0,1] op_sel_hi:[1,1]
    v_pk_mul_f32 v[30:31], v[30:31], v[40:41] op_sel:[0,1] op_sel_hi:[1,1]
    v_and_or_b32 v28, v28, v45, s90
    v_and_or_b32 v29, v29, v45, s91
    v_and_or_b32 v30, v30, v45, s92
    v_and_or_b32 v31, v31, v45, s93
    s_mov_b64 exec, s[62:63]
    buffer_store_dwordx4 v[28:31], v14, s[68:71], s15 offen sc1
    s_not_b64 exec, exec
    s_waitcnt vmcnt(1)
    v_mov_b32 v76, v72
    v_mov_b32 v84, v28
    v_mov_b32 v77, v73
    v_mov_b32 v85, v29
    v_mov_b32 v78, v74
    v_mov_b32 v86, v30
    v_mov_b32 v79, v75
    v_mov_b32 v87, v31
    s_mov_b64 exec, -1
    v_xor_b32 v36, s90, v84
    v_xor_b32 v37, s91, v85
    v_xor_b32 v38, s92, v86
    v_xor_b32 v39, s93, v87
    v_or3_b32 v26, v36, v37, v38
    v_or_b32 v26, v26, v39
    v_cmp_ne_u32_sdwa vcc, v26, v27 src0_sel:BYTE_0 src1_sel:DWORD
    s_cbranch_vccz L_bfirst
    s_mov_b64 exec, vcc
    buffer_load_dwordx4 v[84:87], v46, s[68:71], s67 offen sc1
    s_mov_b64 exec, -1
    v_xor_b32 v36, s90, v76
    v_xor_b32 v37, s91, v77
    v_xor_b32 v38, s92, v78
    v_xor_b32 v39, s93, v79
    v_or3_b32 v26, v36, v37, v38
    v_or_b32 v26, v26, v39
    v_cmp_ne_u32_sdwa vcc, v26, v27 src0_sel:BYTE_0 src1_sel:DWORD
    s_cbranch_vccz L_a0
    s_mov_b64 exec, vcc
    buffer_load_dwordx4 v[76:79], v46, s[68:71], s66 offen sc1
    s_mov_b64 exec, -1
    s_add_u32 s83, s83, 1
    s_cmp_gt_u32 s83, 4194304
    s_cbranch_scc1 L_end
L_r1:
    s_waitcnt vmcnt(1)
    v_xor_b32 v36, s90, v84
    v_xor_b32 v37, s91, v85
    v_xor_b32 v38, s92, v86
    v_xor_b32 v39, s93, v87
    v_or3_b32 v26, v36, v37, v38
    v_or_b32 v26, v26, v39
    v_cmp_ne_u32_sdwa vcc, v26, v27 src0_sel:BYTE_0 src1_sel:DWORD
    s_cbranch_vccz L_bdone
    s_mov_b64 exec, vcc
    buffer_load_dwordx4 v[84:87], v46, s[68:71], s67 offen sc1
    s_mov_b64 exec, -1
    s_add_u32 s83, s83, 1
    s_cmp_gt_u32 s83, 4194304
    s_cbranch_scc1 L_end
    s_waitcnt vmcnt(1)
    v_xor_b32 v36, s90, v76
    v_xor_b32 v37, s91, v77
    v_xor_b32 v38, s92, v78
    v_xor_b32 v39, s93, v79
    v_or3_b32 v26, v36, v37, v38
    v_or_b32 v26, v26, v39
    v_cmp_ne_u32_sdwa vcc, v26, v27 src0_sel:BYTE_0 src1_sel:DWORD
    s_cbranch_vccz L_a1
    s_mov_b64 exec, vcc
    buffer_load_dwordx4 v[76:79], v46, s[68:71], s66 offen sc1
    s_mov_b64 exec, -1
    s_add_u32 s83, s83, 1
    s_cmp_gt_u32 s83, 4194304
    s_cbranch_scc1 L_end
    s_branch L_r1
L_a0:
    v_permlane32_swap_b32 v36, v37
    v_permlane32_swap_b32 v38, v39
    v_add_f32 v36, v36, v37
    v_add_f32 v38, v38, v39
    s_nop 1
    v_permlane16_swap_b32 v36, v38
    v_add_f32 v36, v36, v38
    s_nop 1
    v_add_f32_dpp v36, v36, v36 row_ror:8 row_mask:0xf bank_mask:0xf
    v_cvt_pk_bf16_f32 v24, v36, v36
L_r2:
L_r2b:
    s_waitcnt vmcnt(0)
    v_xor_b32 v36, s90, v84
    v_xor_b32 v37, s91, v85
    v_xor_b32 v38, s92, v86
    v_xor_b32 v39, s93, v87
    v_or3_b32 v26, v36, v37, v38
    v_or_b32 v26, v26, v39
    v_cmp_ne_u32_sdwa vcc, v26, v27 src0_sel:BYTE_0 src1_sel:DWORD
    s_cbranch_vccz L_sumb
    s_mov_b64 exec, vcc
    buffer_load_dwordx4 v[84:87], v46, s[68:71], s67 offen sc1
    s_mov_b64 exec, -1
    s_add_u32 s83, s83, 1
    s_cmp_gt_u32 s83, 4194304
    s_cbranch_scc1 L_end
    s_branch L_r2
L_a1:
    v_permlane32_swap_b32 v36, v37
    v_permlane32_swap_b32 v38, v39
    v_add_f32 v36, v36, v37
    v_add_f32 v38, v38, v39
    s_nop 1
    v_permlane16_swap_b32 v36, v38
    v_add_f32 v36, v36, v38
    s_nop 1
    v_add_f32_dpp v36, v36, v36 row_ror:8 row_mask:0xf bank_mask:0xf
    v_cvt_pk_bf16_f32 v24, v36, v36
    s_branch L_r2b
L_bdone:
    s_waitcnt vmcnt(0)
L_bfirst:
    v_permlane32_swap_b32 v36, v37
    v_permlane32_swap_b32 v38, v39
    v_add_f32 v36, v36, v37
    v_add_f32 v38, v38, v39
    s_nop 1
    v_permlane16_swap_b32 v36, v38
    v_add_f32 v36, v36, v38
    s_nop 1
    v_add_f32_dpp v36, v36, v36 row_ror:8 row_mask:0xf bank_mask:0xf
    v_cvt_pk_bf16_f32 v26, v36, v36
    s_mov_b64 exec, s[64:65]
    buffer_store_short v26, v16, s[72:75], s14 offen offset:2048
    s_mov_b64 exec, -1
L_cha:
    v_xor_b32 v36, s90, v76
    v_xor_b32 v37, s91, v77
    v_xor_b32 v38, s92, v78
    v_xor_b32 v39, s93, v79
    v_or3_b32 v26, v36, v37, v38
    v_or_b32 v26, v26, v39
    v_cmp_ne_u32_sdwa vcc, v26, v27 src0_sel:BYTE_0 src1_sel:DWORD
    s_cbranch_vccz L_suma
    s_mov_b64 exec, vcc
    buffer_load_dwordx4 v[76:79], v46, s[68:71], s66 offen sc1
    s_mov_b64 exec, -1
    s_add_u32 s83, s83, 1
    s_cmp_gt_u32 s83, 4194304
    s_cbranch_scc1 L_end
    s_waitcnt vmcnt(0)
    s_branch L_cha
L_suma:
    v_permlane32_swap_b32 v36, v37
    v_permlane32_swap_b32 v38, v39
    v_add_f32 v36, v36, v37
    v_add_f32 v38, v38, v39
    s_nop 1
    v_permlane16_swap_b32 v36, v38
    v_add_f32 v36, v36, v38
    s_nop 1
    v_add_f32_dpp v36, v36, v36 row_ror:8 row_mask:0xf bank_mask:0xf
    v_cvt_pk_bf16_f32 v26, v36, v36
    s_mov_b64 exec, s[64:65]
    buffer_store_short v26, v16, s[72:75], s14 offen offset:0
    s_endpgm
L_sumb:
    v_permlane32_swap_b32 v36, v37
    v_permlane32_swap_b32 v38, v39
    v_add_f32 v36, v36, v37
    v_add_f32 v38, v38, v39
    s_nop 1
    v_permlane16_swap_b32 v36, v38
    v_add_f32 v36, v36, v38
    s_nop 1
    v_add_f32_dpp v36, v36, v36 row_ror:8 row_mask:0xf bank_mask:0xf
    v_cvt_pk_bf16_f32 v26, v36, v36
    s_mov_b64 exec, s[64:65]
    buffer_store_short v26, v16, s[72:75], s14 offen offset:2048
    buffer_store_short v24, v16, s[72:75], s14 offen
L_end:
    s_endpgm
.section .rodata,"a"
.p2align 6
.amdhsa_kernel standalone__kv_cache_quant_pre_rope_vs_post_rope__sampling_kernel
      .amdhsa_next_free_vgpr 152
      .amdhsa_next_free_sgpr 98
      .amdhsa_accum_offset 152
      .amdhsa_group_segment_fixed_size 0
      .amdhsa_kernarg_size 112
      .amdhsa_user_sgpr_count 2
      .amdhsa_user_sgpr_kernarg_segment_ptr 1
      .amdhsa_system_sgpr_workgroup_id_x 1
      .amdhsa_float_denorm_mode_32 3
.end_amdhsa_kernel
```
